```python
import torch

def _softmax(x, axis=-1):
    return torch.softmax(x, dim=axis)
def _gelu(x):
    return torch.nn.functional.gelu(x, approximate="tanh")
def _silu(x):
    return torch.nn.functional.silu(x)
def _sigmoid(x):
    return torch.sigmoid(x)
def _layernorm(x, axis=-1, eps=1e-5):
    m = x.mean(dim=axis, keepdim=True)
    v = x.var(dim=axis, keepdim=True, unbiased=False)
    return (x - m) / torch.sqrt(v + eps)
def _scatter_add(tgt, idx, src, axis=0):
    return tgt.clone().index_add_(axis, idx, src)
def _segment_sum(src, seg, n):
    out = torch.zeros((n,) + src.shape[1:], dtype=src.dtype)
    return out.index_add_(0, seg, src)
def _pad(x, pw):
    flat = tuple(v for pair in reversed(pw) for v in pair)
    return torch.nn.functional.pad(x, flat)

kernel_name = 'gated_mix__ssm_conv_s4__linear_attn_block__prompt'

def setup_inputs():

    _w = (lambda a: (lambda t: t.to(torch.bfloat16) if t.is_floating_point() else t)(torch.as_tensor(a)))
    def _A_setup():
        B, L, D, N = 1, 2048, 640, 128
        A_re = -(lambda _x: torch.exp(torch.as_tensor(_x)))((lambda *s: torch.randn(*s, dtype=torch.bfloat16) * 3.2)(D, N))
        A_im = torch.pi * (lambda *s: torch.randn(*s, dtype=torch.bfloat16) * 0.05)(D, N)
        B_re = (lambda *s: torch.randn(*s, dtype=torch.bfloat16) * 0.2)(D, N)
        B_im = (lambda *s: torch.randn(*s, dtype=torch.bfloat16) * 0.2)(D, N)
        C_re = (lambda *s: torch.randn(*s, dtype=torch.bfloat16) * 0.2)(D, N)
        C_im = (lambda *s: torch.randn(*s, dtype=torch.bfloat16) * 0.2)(D, N)
        log_dt = (lambda *s: torch.randn(*s, dtype=torch.bfloat16) * 0.05)(D) * 0.5 - 4.0
        Dskip = (lambda *s: torch.randn(*s, dtype=torch.bfloat16) * 0.05)(D)
        return {
            "u": _w((lambda *s: torch.randn(*s, dtype=torch.bfloat16) * 0.05)(B, L, D)),
            "A_re": _w(A_re),
            "A_im": _w(A_im),
            "B_re": _w(B_re),
            "B_im": _w(B_im),
            "C_re": _w(C_re),
            "C_im": _w(C_im),
            "log_dt": _w(log_dt),
            "Dskip": _w(Dskip),
        }
    _A_in = _A_setup()

    def _B_setup():
        B, S, D = 1, 2048, 640
        return {
            "x": _w((lambda *s: torch.randn(*s, dtype=torch.bfloat16) * 0.05)(B, S, D)),
            "wqkv": _w((lambda *s: torch.randn(*s, dtype=torch.bfloat16) * 0.8)(D, 3 * D)),
            "wo": _w((lambda *s: torch.randn(*s, dtype=torch.bfloat16) * 0.05)(D, D)),
        }
    _B_in = _B_setup()

    return {
        "A_u": _A_in["u"],
        "A_A_re": _A_in["A_re"],
        "A_A_im": _A_in["A_im"],
        "A_B_re": _A_in["B_re"],
        "A_B_im": _A_in["B_im"],
        "A_C_re": _A_in["C_re"],
        "A_C_im": _A_in["C_im"],
        "A_log_dt": _A_in["log_dt"],
        "A_Dskip": _A_in["Dskip"],
        "B_x": _B_in["x"],
        "B_wqkv": _B_in["wqkv"],
        "B_wo": _B_in["wo"],
        "gate_w": _w((lambda *s: torch.randn(*s, dtype=torch.bfloat16) * 0.05)(640) * 16.0),
    }

def reference(A_u, A_A_re, A_A_im, A_B_re, A_B_im, A_C_re, A_C_im, A_log_dt, A_Dskip, B_x, B_wqkv, B_wo, gate_w):
    def _A_ref(u, A_re, A_im, B_re, B_im, C_re, C_im, log_dt, Dskip):
        Bsz, L, D = u.shape
        dt = torch.exp(log_dt)[:, None]
        A = A_re + 1j * A_im
        Bc = B_re + 1j * B_im
        Cc = C_re + 1j * C_im
        logdA = dt * A
        dB = dt * Bc
        l = (lambda x, dt: x.to(dt))(torch.arange(L), A_re.dtype)
        P = torch.exp(logdA[:, :, None] * l[None, None, :])
        K = torch.einsum("dn,dnl,dn->dl", Cc, P, dB).real
        L2 = 2 * L
        Kp = _pad(K, ((0, 0), (0, L)))
        up = (lambda x, *d: x.permute(*d))(u, 0, 2, 1)
        up = _pad(up, ((0, 0), (0, 0), (0, L)))
        Kf = (lambda x, axes=(-2,-1): torch.fft.rfft2(x.float(), dim=axes))(Kp[:, None, :], axes=(-2, -1))
        Uf = (lambda x, axes=(-2,-1): torch.fft.rfft2(x.float(), dim=axes))(up[:, :, None, :], axes=(-2, -1))
        Yf = Uf * Kf[None, :, :, :]
        y = (lambda x, s, axes=(-2,-1): torch.fft.irfft2(x, s=s, dim=axes).to(torch.bfloat16))(Yf, (1, L2), axes=(-2, -1))[:, :, 0, :L]
        y = (lambda x, *d: x.permute(*d))(y, 0, 2, 1) + u * Dskip[None, None, :]
        return y

    def _B_ref(x, wqkv, wo):
        B, S, D = x.shape
        H = 32; Dh = D // H
        qkv = (lambda x, *d: x.permute(*d))((x @ wqkv).reshape(B, S, 3, H, Dh), 2, 0, 3, 1, 4)
        q, k, v = qkv[0], qkv[1], qkv[2]
        phi = lambda t: torch.where(t > 0, t + 1, torch.exp(t)) + 1e-6
        pq, pk = phi(q), phi(k)
        kv = torch.einsum("bhsd,bhse->bhde", pk, v)
        z = torch.einsum("bhsd->bhd", pk)
        num = torch.einsum("bhqd,bhde->bhqe", pq, kv)
        den = torch.einsum("bhqd,bhd->bhq", pq, z)[..., None] + 1e-6
        o = num / den
        return (lambda x, *d: x.permute(*d))(o, 0, 2, 1, 3).reshape(B, S, D) @ wo

    x = A_u
    g = _sigmoid((x * gate_w).sum(-1, keepdims=True))
    a = _A_ref(x, A_A_re, A_A_im, A_B_re, A_B_im, A_C_re, A_C_im, A_log_dt, A_Dskip)
    b = _B_ref(x, B_wqkv, B_wo)
    return g * a + (1 - g) * b
```

```asm
; @launch grid=(256,1,1) block=(256,1,1) lds=163840
.amdgcn_target "amdgcn-amd-amdhsa--gfx950"
.text
.globl gated_mix__ssm_conv_s4__linear_attn_block__prompt_kernel
.p2align 8
.type gated_mix__ssm_conv_s4__linear_attn_block__prompt_kernel,@function
gated_mix__ssm_conv_s4__linear_attn_block__prompt_kernel:

  s_cmp_ge_u32 s2, 256
  s_cbranch_scc1 L_end
  s_mov_b32 s93, 0
  s_getpc_b64 s[76:77]
  s_lshr_b32 s6, s2, 3
  s_cmp_ge_u32 s6, 2
  s_cbranch_scc1 L_nocp
  s_lshl_b32 s6, s6, 15
  v_lshlrev_b32 v250, 7, v0
  v_add_u32 v250, s6, v250
  v_min_u32 v250, 34000, v250
  global_load_dword v251, v250, s[76:77]
L_nocp:
  s_load_dwordx4 s[16:19], s[0:1], 8
  s_load_dwordx4 s[20:23], s[0:1], 24
  s_load_dwordx4 s[24:27], s[0:1], 40
  s_load_dwordx4 s[60:63], s[0:1], 56
  s_and_b32 s5, s2, 7
  s_lshr_b32 s6, s2, 3
  s_mov_b32 s89, s5
  s_mov_b32 s87, s6
  s_cmp_lt_u32 s6, 8
  s_cbranch_scc1 L_help
  s_sub_u32 s6, s6, 8
  s_and_b32 s7, s6, 3
  s_lshr_b32 s4, s6, 2
  s_lshr_b32 s3, s5, 1
  s_lshl_b32 s3, s3, 2
  s_add_u32 s3, s3, s7
  s_and_b32 s5, s5, 1
  s_mul_i32 s5, s5, 6
  s_add_u32 s4, s4, s5
  s_mul_i32 s92, s3, 12
  s_add_u32 s92, s92, s4
  s_add_u32 s90, s92, 128
  s_mov_b32 s91, 1
  s_mov_b32 s85, 113536
  s_load_dwordx2 s[8:9], s[0:1], 0
  s_load_dwordx2 s[12:13], s[0:1], 80
  s_load_dwordx4 s[48:51], s[0:1], 112
  v_and_b32 v11, 63, v0
  v_lshrrev_b32 v12, 6, v0
  s_nop 0
  v_readfirstlane_b32 s28, v12
  v_and_b32 v15, 15, v11
  v_lshrrev_b32 v16, 4, v11
  s_lshr_b32 s53, s28, 1
  s_and_b32 s54, s28, 1
  s_mul_i32 s30, s4, 160
  s_add_u32 s31, s30, 2400
  s_add_u32 s30, s30, 1280
  s_sub_u32 s32, s4, 8
  s_mul_i32 s32, s32, 320
  s_cmp_ge_u32 s4, 8
  s_cselect_b32 s30, s32, s30
  s_cselect_b32 s31, s32, s31
  s_mov_b32 s44, 1949717008
  s_mov_b32 s45, 152
  s_mov_b32 s46, 1985229328
  s_cselect_b32 s44, s46, s44
  s_lshl_b32 s33, s3, 7
  s_mov_b32 s47, 0x78
  v_lshrrev_b32 v12, 2, v11
  v_lshrrev_b32 v13, 4, v11
  v_lshlrev_b32 v13, 1, v13
  v_lshrrev_b32 v13, v13, s47
  v_xor_b32 v13, v13, v11
  v_and_b32 v13, 3, v13
  s_lshl_b32 s34, s28, 5
  s_add_u32 s34, s34, s33
  v_add_u32 v12, s34, v12
  v_mul_u32_u24 v12, 1280, v12
  v_lshl_add_u32 v152, v13, 4, v12
  v_add_u32 v153, 20480, v152
  v_lshrrev_b32 v13, 2, v15
  v_lshlrev_b32 v13, 1, v13
  v_lshrrev_b32 v13, v13, s47
  v_xor_b32 v13, v13, v16
  v_and_b32 v13, 3, v13
  v_lshlrev_b32 v12, 6, v15
  v_lshl_add_u32 v12, v13, 4, v12
  s_lshl_b32 s34, s53, 12
  v_add_u32 v159, s34, v12
  s_mul_i32 s34, s28, 160
  v_add_u32 v12, s34, v11
  v_mul_u32_u24 v13, 3277, v12
  v_lshrrev_b32 v13, 16, v13
  v_mul_u32_u24 v14, 20, v13
  v_sub_u32 v12, v12, v14
  v_lshrrev_b32 v14, 3, v13
  v_and_b32 v14, 1, v14
  v_lshrrev_b32 v17, 1, v12
  v_xor_b32 v17, v17, v14
  v_lshlrev_b32 v17, 2, v17
  v_lshrrev_b64 v[20:21], v17, s[44:45]
  v_and_b32 v17, 15, v20
  v_and_b32 v12, 1, v12
  v_lshl_add_u32 v12, v17, 1, v12
  v_cmp_gt_u32 vcc, 10, v12
  v_mov_b32 v14, s31
  v_mov_b32 v17, s30
  v_cndmask_b32 v14, v14, v17, vcc
  v_lshl_add_u32 v14, v12, 4, v14
  v_mul_u32_u24 v13, 3840, v13
  v_add_u32 v154, v13, v14
  v_add_u32 v12, s34, v11
  v_add_u32 v12, 64, v12
  v_mul_u32_u24 v13, 3277, v12
  v_lshrrev_b32 v13, 16, v13
  v_mul_u32_u24 v14, 20, v13
  v_sub_u32 v12, v12, v14
  v_lshrrev_b32 v14, 3, v13
  v_and_b32 v14, 1, v14
  v_lshrrev_b32 v17, 1, v12
  v_xor_b32 v17, v17, v14
  v_lshlrev_b32 v17, 2, v17
  v_lshrrev_b64 v[20:21], v17, s[44:45]
  v_and_b32 v17, 15, v20
  v_and_b32 v12, 1, v12
  v_lshl_add_u32 v12, v17, 1, v12
  v_cmp_gt_u32 vcc, 10, v12
  v_mov_b32 v14, s31
  v_mov_b32 v17, s30
  v_cndmask_b32 v14, v14, v17, vcc
  v_lshl_add_u32 v14, v12, 4, v14
  v_mul_u32_u24 v13, 3840, v13
  v_add_u32 v155, v13, v14
  v_add_u32 v12, s34, v11
  v_add_u32 v12, 128, v12
  v_mul_u32_u24 v13, 3277, v12
  v_lshrrev_b32 v13, 16, v13
  v_mul_u32_u24 v14, 20, v13
  v_sub_u32 v12, v12, v14
  v_lshrrev_b32 v14, 3, v13
  v_and_b32 v14, 1, v14
  v_lshrrev_b32 v17, 1, v12
  v_xor_b32 v17, v17, v14
  v_lshlrev_b32 v17, 2, v17
  v_lshrrev_b64 v[20:21], v17, s[44:45]
  v_and_b32 v17, 15, v20
  v_and_b32 v12, 1, v12
  v_lshl_add_u32 v12, v17, 1, v12
  v_cmp_gt_u32 vcc, 10, v12
  v_mov_b32 v14, s31
  v_mov_b32 v17, s30
  v_cndmask_b32 v14, v14, v17, vcc
  v_lshl_add_u32 v14, v12, 4, v14
  v_mul_u32_u24 v13, 3840, v13
  v_add_u32 v156, v13, v14
  v_lshrrev_b32 v12, 2, v15
  v_lshl_add_u32 v12, v16, 3, v12
  v_mul_u32_u24 v12, 320, v12
  v_and_b32 v13, 3, v15
  v_lshl_add_u32 v12, v13, 3, v12
  s_mul_i32 s34, s54, 160
  v_add_u32 v12, s34, v12
  v_and_b32 v13, 1, v16
  v_lshlrev_b32 v13, 5, v13
  v_sub_u32 v14, 0, v13
  s_cmp_eq_u32 s54, 0
  s_cselect_b64 vcc, -1, 0
  v_cndmask_b32 v17, v14, v13, vcc
  v_add_u32 v157, v12, v17
  v_sub_u32 v158, v12, v17
  s_lshl_b32 s35, s28, 11
  s_mul_i32 s36, s28, 2560
  s_add_u32 s36, s36, 8192
  s_waitcnt lgkmcnt(0)
  s_mov_b32 s10, 2621440
  s_mov_b32 s11, 0x20000
  s_mov_b32 s14, 2457600
  s_mov_b32 s15, 0x20000
  s_mov_b32 s37, 0
  s_mov_b32 s38, 0
  v_mbcnt_lo_u32_b32 v240, -1, 0
  v_mbcnt_hi_u32_b32 v240, -1, v240
  s_lshl_b32 s80, s90, 9
  s_lshl_b32 s81, s28, 7
  s_add_u32 s80, s80, s81
  v_lshl_add_u32 v240, v240, 1, s80
  s_lshl_b32 s81, s90, 2
  s_lshr_b32 s82, s28, 1
  s_lshl_b32 s82, s82, 1
  s_add_u32 s81, s81, s82
  v_mov_b32 v241, s81
  global_load_ushort v232, v240, s[16:17]
  global_load_ushort v233, v240, s[18:19]
  global_load_ushort v234, v240, s[20:21]
  global_load_ushort v235, v240, s[22:23]
  global_load_ushort v236, v240, s[24:25]
  global_load_ushort v237, v240, s[26:27]
  global_load_ushort v238, v241, s[60:61]
  global_load_ushort v239, v241, s[62:63]
  s_and_b32 s39, s89, 1
  s_lshr_b32 s40, s89, 1
  s_mul_i32 s40, s40, 655360
  s_lshl_b32 s34, s87, 8
  v_and_b32 v33, 15, v0
  v_add_u32 v35, 10, v33
  v_add_u32 v36, 12, v33
  v_cmp_gt_u32 vcc, 8, v33
  s_nop 1
  v_cndmask_b32 v35, v36, v35, vcc
  v_add_u32 v36, 14, v33
  v_add_u32 v37, 7, v33
  v_cmp_gt_u32 vcc, 13, v33
  s_nop 1
  v_cndmask_b32 v36, v36, v37, vcc
  v_cmp_gt_u32 vcc, 10, v33
  s_nop 1
  v_cndmask_b32 v36, v36, v33, vcc
  s_cmp_eq_u32 s39, 0
  s_cselect_b64 vcc, -1, 0
  v_cndmask_b32 v35, v36, v35, vcc
  v_lshlrev_b32 v35, 7, v35
  v_add_u32 v30, s34, v0
  v_lshlrev_b32 v32, 7, v30
  v_add_u32 v32, s40, v32
  v_subrev_u32 v34, 5120, v30
  v_lshrrev_b32 v34, 4, v34
  v_mul_u32_u24 v34, 3840, v34
  v_add_u32 v34, v34, v35
  v_readfirstlane_b32 s29, v30
  s_nop 0
  s_cmp_ge_u32 s29, 5120
  s_cbranch_scc1 L_tb_1
  buffer_load_dword v200, v32, s[8:11], 0 offen
  s_branch L_te_2
L_tb_1:
  buffer_load_dword v200, v34, s[12:15], 0 offen
L_te_2:
  v_add_u32 v30, s34, v0
  v_add_u32 v30, 8192, v30
  v_min_u32 v30, 15359, v30
  v_lshlrev_b32 v32, 7, v30
  v_add_u32 v32, s40, v32
  v_subrev_u32 v34, 5120, v30
  v_lshrrev_b32 v34, 4, v34
  v_mul_u32_u24 v34, 3840, v34
  v_add_u32 v34, v34, v35
  v_readfirstlane_b32 s29, v30
  s_nop 0
  s_cmp_ge_u32 s29, 5120
  s_cbranch_scc1 L_tb_3
  buffer_load_dword v201, v32, s[8:11], 0 offen
  s_branch L_te_4
L_tb_3:
  buffer_load_dword v201, v34, s[12:15], 0 offen
L_te_4:
  s_lshr_b32 s97, s28, 1
  s_and_b32 s98, s28, 1
  s_lshl_b32 s99, s90, 1
  s_add_u32 s99, s99, s97
  s_mul_i32 s95, s28, 4608
  s_add_u32 s95, s95, 17344
  s_add_u32 s95, s95, s85
  s_mul_i32 s94, s97, 4576
  s_add_u32 s94, s94, s85
  s_mul_i32 s96, s97, 8288
  s_add_u32 s96, s96, 17344
  s_add_u32 s96, s96, s85
  v_mbcnt_lo_u32_b32 v1, -1, 0
  v_mbcnt_hi_u32_b32 v1, -1, v1
  v_and_b32 v4, 15, v1
  v_lshrrev_b32 v5, 4, v1
  v_mov_b32 v6, 0
  v_mov_b32 v7, 0
  v_min_u32 v2, 59, v1
  v_lshl_add_u32 v2, v2, 3, s94
  ds_write_b64 v2, v[6:7] offset:4096
  v_lshl_add_u32 v6, v1, 2, s95
  v_add_u32 v7, 1152, v6
  v_add_u32 v8, 2304, v6
  v_add_u32 v9, 3456, v6
  v_mul_u32_u24 v10, 288, v4
  v_lshl_add_u32 v10, v5, 4, v10
  v_add_u32 v10, s95, v10
  s_lshl_b32 s100, s28, 11
  v_lshl_add_u32 v11, v1, 4, s100
  v_xor_b32 v12, 2048, v11
  s_add_u32 s100, s85, 9152
  v_add_u32 v11, s100, v11
  v_add_u32 v12, s100, v12
  s_mov_b32 s44, 1069066811
  s_mov_b32 s45, 849703008
  s_mov_b32 s46, 1060205080
  s_mov_b32 s47, 1042479491
  s_waitcnt vmcnt(2)
  v_lshlrev_b32 v232, 16, v232
  v_lshlrev_b32 v233, 16, v233
  v_lshlrev_b32 v234, 16, v234
  v_lshlrev_b32 v235, 16, v235
  v_lshlrev_b32 v236, 16, v236
  v_lshlrev_b32 v237, 16, v237
  v_lshlrev_b32 v238, 16, v238
  v_lshlrev_b32 v239, 16, v239
  v_mul_f32 v2, s44, v238
  v_fma_f32 v3, v238, s44, -v2
  v_fma_f32 v3, v238, s45, v3
  v_exp_f32 v2, v2
  v_mul_f32 v3, s46, v3
  v_fma_f32 v2, v2, v3, v2
  v_cvt_pk_bf16_f32 v2, v2, v2
  v_lshlrev_b32 v238, 16, v2
  v_mul_f32 v232, v238, v232
  v_mul_f32 v233, v238, v233
  v_mul_f32 v232, s44, v232
  v_mul_f32 v233, s47, v233
  v_mul_f32 v234, v238, v234
  v_mul_f32 v235, v238, v235
  v_mul_f32 v14, v236, v234
  v_fma_f32 v14, -v237, v235, v14
  v_mul_f32 v15, v236, v235
  v_fma_f32 v15, v237, v234, v15
  v_mul_f32 v2, 1090519040, v232
  v_mul_f32 v3, 1090519040, v233
  v_exp_f32 v2, v2
  v_fract_f32 v3, v3
  v_cos_f32 v24, v3
  v_sin_f32 v25, v3
  v_mul_f32 v24, v2, v24
  v_mul_f32 v25, -v2, v25
  v_mov_b32 v26, 1.0
  v_mov_b32 v27, 0
  v_cvt_pk_bf16_f32 v13, v26, v27
  v_cvt_pk_bf16_f32 v16, v24, v25
  ds_write2_b32 v6, v13, v16 offset0:0 offset1:72
  v_pk_mul_f32 v[22:23], v[24:25], v[24:25] op_sel:[0,0] op_sel_hi:[1,0]
  v_pk_fma_f32 v[22:23], v[24:25], v[24:25], v[22:23] op_sel:[1,1,0] op_sel_hi:[0,1,1] neg_lo:[1,0,0]
  v_cvt_pk_bf16_f32 v17, v22, v23
  v_pk_mul_f32 v[20:21], v[22:23], v[24:25] op_sel:[0,0] op_sel_hi:[1,0]
  v_pk_fma_f32 v[20:21], v[22:23], v[24:25], v[20:21] op_sel:[1,1,0] op_sel_hi:[0,1,1] neg_lo:[1,0,0]
  v_cvt_pk_bf16_f32 v18, v20, v21
  ds_write2_b32 v6, v17, v18 offset0:144 offset1:216
  v_pk_mul_f32 v[22:23], v[20:21], v[24:25] op_sel:[0,0] op_sel_hi:[1,0]
  v_pk_fma_f32 v[22:23], v[20:21], v[24:25], v[22:23] op_sel:[1,1,0] op_sel_hi:[0,1,1] neg_lo:[1,0,0]
  v_cvt_pk_bf16_f32 v13, v22, v23
  v_pk_mul_f32 v[20:21], v[22:23], v[24:25] op_sel:[0,0] op_sel_hi:[1,0]
  v_pk_fma_f32 v[20:21], v[22:23], v[24:25], v[20:21] op_sel:[1,1,0] op_sel_hi:[0,1,1] neg_lo:[1,0,0]
  v_cvt_pk_bf16_f32 v16, v20, v21
  ds_write2_b32 v7, v13, v16 offset0:0 offset1:72
  v_pk_mul_f32 v[22:23], v[20:21], v[24:25] op_sel:[0,0] op_sel_hi:[1,0]
  v_pk_fma_f32 v[22:23], v[20:21], v[24:25], v[22:23] op_sel:[1,1,0] op_sel_hi:[0,1,1] neg_lo:[1,0,0]
  v_cvt_pk_bf16_f32 v17, v22, v23
  v_pk_mul_f32 v[20:21], v[22:23], v[24:25] op_sel:[0,0] op_sel_hi:[1,0]
  v_pk_fma_f32 v[20:21], v[22:23], v[24:25], v[20:21] op_sel:[1,1,0] op_sel_hi:[0,1,1] neg_lo:[1,0,0]
  v_cvt_pk_bf16_f32 v18, v20, v21
  ds_write2_b32 v7, v17, v18 offset0:144 offset1:216
  v_mul_f32 v2, 1115684864, v232
  v_mul_f32 v3, 1115684864, v233
  v_exp_f32 v2, v2
  v_fract_f32 v3, v3
  v_cos_f32 v26, v3
  v_sin_f32 v27, v3
  v_mul_f32 v26, v2, v26
  v_mul_f32 v27, -v2, v27
  v_cvt_pk_bf16_f32 v13, v26, v27
  v_pk_mul_f32 v[22:23], v[26:27], v[24:25] op_sel:[0,0] op_sel_hi:[1,0]
  v_pk_fma_f32 v[22:23], v[26:27], v[24:25], v[22:23] op_sel:[1,1,0] op_sel_hi:[0,1,1] neg_lo:[1,0,0]
  v_cvt_pk_bf16_f32 v16, v22, v23
  ds_write2_b32 v8, v13, v16 offset0:0 offset1:72
  v_pk_mul_f32 v[20:21], v[22:23], v[24:25] op_sel:[0,0] op_sel_hi:[1,0]
  v_pk_fma_f32 v[20:21], v[22:23], v[24:25], v[20:21] op_sel:[1,1,0] op_sel_hi:[0,1,1] neg_lo:[1,0,0]
  v_cvt_pk_bf16_f32 v17, v20, v21
  v_pk_mul_f32 v[22:23], v[20:21], v[24:25] op_sel:[0,0] op_sel_hi:[1,0]
  v_pk_fma_f32 v[22:23], v[20:21], v[24:25], v[22:23] op_sel:[1,1,0] op_sel_hi:[0,1,1] neg_lo:[1,0,0]
  v_cvt_pk_bf16_f32 v18, v22, v23
  ds_write2_b32 v8, v17, v18 offset0:144 offset1:216
  v_pk_mul_f32 v[20:21], v[22:23], v[24:25] op_sel:[0,0] op_sel_hi:[1,0]
  v_pk_fma_f32 v[20:21], v[22:23], v[24:25], v[20:21] op_sel:[1,1,0] op_sel_hi:[0,1,1] neg_lo:[1,0,0]
  v_cvt_pk_bf16_f32 v13, v20, v21
  v_pk_mul_f32 v[22:23], v[20:21], v[24:25] op_sel:[0,0] op_sel_hi:[1,0]
  v_pk_fma_f32 v[22:23], v[20:21], v[24:25], v[22:23] op_sel:[1,1,0] op_sel_hi:[0,1,1] neg_lo:[1,0,0]
  v_cvt_pk_bf16_f32 v16, v22, v23
  ds_write2_b32 v9, v13, v16 offset0:0 offset1:72
  v_pk_mul_f32 v[20:21], v[22:23], v[24:25] op_sel:[0,0] op_sel_hi:[1,0]
  v_pk_fma_f32 v[20:21], v[22:23], v[24:25], v[20:21] op_sel:[1,1,0] op_sel_hi:[0,1,1] neg_lo:[1,0,0]
  v_cvt_pk_bf16_f32 v17, v20, v21
  v_pk_mul_f32 v[22:23], v[20:21], v[24:25] op_sel:[0,0] op_sel_hi:[1,0]
  v_pk_fma_f32 v[22:23], v[20:21], v[24:25], v[22:23] op_sel:[1,1,0] op_sel_hi:[0,1,1] neg_lo:[1,0,0]
  v_cvt_pk_bf16_f32 v18, v22, v23
  ds_write2_b32 v9, v17, v18 offset0:144 offset1:216
  ds_read_b128 v[24:27], v10 offset:0
  ds_read_b128 v[28:31], v10 offset:64
  ds_read_b128 v[32:35], v10 offset:128
  ds_read_b128 v[36:39], v10 offset:192
  v_mul_f32 v2, 1124073472, v232
  v_mul_f32 v3, 1124073472, v233
  v_exp_f32 v2, v2
  v_fract_f32 v3, v3
  v_cos_f32 v68, v3
  v_sin_f32 v69, v3
  v_mul_f32 v68, v2, v68
  v_mul_f32 v69, v2, v69
  v_mul_f32 v2, 1140850688, v232
  v_mul_f32 v3, 1140850688, v233
  v_exp_f32 v2, v2
  v_fract_f32 v3, v3
  v_cos_f32 v70, v3
  v_sin_f32 v71, v3
  v_mul_f32 v70, v2, v70
  v_mul_f32 v71, v2, v71
  v_pk_mul_f32 v[72:73], v[14:15], v[68:69] op_sel:[0,0] op_sel_hi:[1,0]
  v_pk_fma_f32 v[72:73], v[14:15], v[68:69], v[72:73] op_sel:[1,1,0] op_sel_hi:[0,1,1] neg_lo:[1,0,0]
  v_pk_mul_f32 v[74:75], v[72:73], v[68:69] op_sel:[0,0] op_sel_hi:[1,0]
  v_pk_fma_f32 v[74:75], v[72:73], v[68:69], v[74:75] op_sel:[1,1,0] op_sel_hi:[0,1,1] neg_lo:[1,0,0]
  v_pk_mul_f32 v[76:77], v[74:75], v[68:69] op_sel:[0,0] op_sel_hi:[1,0]
  v_pk_fma_f32 v[76:77], v[74:75], v[68:69], v[76:77] op_sel:[1,1,0] op_sel_hi:[0,1,1] neg_lo:[1,0,0]
  v_pk_mul_f32 v[78:79], v[14:15], v[70:71] op_sel:[0,0] op_sel_hi:[1,0]
  v_pk_fma_f32 v[78:79], v[14:15], v[70:71], v[78:79] op_sel:[1,1,0] op_sel_hi:[0,1,1] neg_lo:[1,0,0]
  v_pk_mul_f32 v[80:81], v[72:73], v[70:71] op_sel:[0,0] op_sel_hi:[1,0]
  v_pk_fma_f32 v[80:81], v[72:73], v[70:71], v[80:81] op_sel:[1,1,0] op_sel_hi:[0,1,1] neg_lo:[1,0,0]
  v_pk_mul_f32 v[82:83], v[74:75], v[70:71] op_sel:[0,0] op_sel_hi:[1,0]
  v_pk_fma_f32 v[82:83], v[74:75], v[70:71], v[82:83] op_sel:[1,1,0] op_sel_hi:[0,1,1] neg_lo:[1,0,0]
  v_pk_mul_f32 v[84:85], v[76:77], v[70:71] op_sel:[0,0] op_sel_hi:[1,0]
  v_pk_fma_f32 v[84:85], v[76:77], v[70:71], v[84:85] op_sel:[1,1,0] op_sel_hi:[0,1,1] neg_lo:[1,0,0]
  v_pk_mul_f32 v[86:87], v[78:79], v[70:71] op_sel:[0,0] op_sel_hi:[1,0]
  v_pk_fma_f32 v[86:87], v[78:79], v[70:71], v[86:87] op_sel:[1,1,0] op_sel_hi:[0,1,1] neg_lo:[1,0,0]
  v_pk_mul_f32 v[88:89], v[86:87], v[70:71] op_sel:[0,0] op_sel_hi:[1,0]
  v_pk_fma_f32 v[88:89], v[86:87], v[70:71], v[88:89] op_sel:[1,1,0] op_sel_hi:[0,1,1] neg_lo:[1,0,0]
  v_cvt_pk_bf16_f32 v13, v86, v87
  v_pk_mul_f32 v[22:23], v[86:87], v[68:69] op_sel:[0,0] op_sel_hi:[1,0]
  v_pk_fma_f32 v[22:23], v[86:87], v[68:69], v[22:23] op_sel:[1,1,0] op_sel_hi:[0,1,1] neg_lo:[1,0,0]
  v_cvt_pk_bf16_f32 v16, v22, v23
  ds_write2_b32 v6, v13, v16 offset0:0 offset1:72
  v_pk_mul_f32 v[20:21], v[22:23], v[68:69] op_sel:[0,0] op_sel_hi:[1,0]
  v_pk_fma_f32 v[20:21], v[22:23], v[68:69], v[20:21] op_sel:[1,1,0] op_sel_hi:[0,1,1] neg_lo:[1,0,0]
  v_cvt_pk_bf16_f32 v17, v20, v21
  v_pk_mul_f32 v[22:23], v[20:21], v[68:69] op_sel:[0,0] op_sel_hi:[1,0]
  v_pk_fma_f32 v[22:23], v[20:21], v[68:69], v[22:23] op_sel:[1,1,0] op_sel_hi:[0,1,1] neg_lo:[1,0,0]
  v_cvt_pk_bf16_f32 v18, v22, v23
  ds_write2_b32 v7, v17, v18 offset0:0 offset1:72
  v_cvt_pk_bf16_f32 v13, v88, v89
  v_pk_mul_f32 v[22:23], v[88:89], v[68:69] op_sel:[0,0] op_sel_hi:[1,0]
  v_pk_fma_f32 v[22:23], v[88:89], v[68:69], v[22:23] op_sel:[1,1,0] op_sel_hi:[0,1,1] neg_lo:[1,0,0]
  v_cvt_pk_bf16_f32 v16, v22, v23
  ds_write2_b32 v8, v13, v16 offset0:0 offset1:72
  v_pk_mul_f32 v[20:21], v[22:23], v[68:69] op_sel:[0,0] op_sel_hi:[1,0]
  v_pk_fma_f32 v[20:21], v[22:23], v[68:69], v[20:21] op_sel:[1,1,0] op_sel_hi:[0,1,1] neg_lo:[1,0,0]
  v_cvt_pk_bf16_f32 v17, v20, v21
  v_pk_mul_f32 v[22:23], v[20:21], v[68:69] op_sel:[0,0] op_sel_hi:[1,0]
  v_pk_fma_f32 v[22:23], v[20:21], v[68:69], v[22:23] op_sel:[1,1,0] op_sel_hi:[0,1,1] neg_lo:[1,0,0]
  v_cvt_pk_bf16_f32 v18, v22, v23
  ds_write2_b32 v9, v17, v18 offset0:0 offset1:72
  v_pk_mul_f32 v[20:21], v[22:23], v[68:69] op_sel:[0,0] op_sel_hi:[1,0]
  v_pk_fma_f32 v[20:21], v[22:23], v[68:69], v[20:21] op_sel:[1,1,0] op_sel_hi:[0,1,1] neg_lo:[1,0,0]
  v_cvt_pk_bf16_f32 v13, v20, v21
  ds_write_b32 v6, v13 offset:576
  ds_read_b128 v[40:43], v10 offset:0
  ds_read_b128 v[44:47], v10 offset:64
  ds_read_b128 v[48:51], v10 offset:128
  ds_read_b128 v[52:55], v10 offset:192
  v_exp_f32 v2, v232
  v_fract_f32 v3, v233
  v_cos_f32 v68, v3
  v_sin_f32 v69, v3
  v_mul_f32 v68, v2, v68
  v_mul_f32 v69, v2, v69
  v_pk_mul_f32 v[70:71], v[68:69], v[68:69] op_sel:[0,0] op_sel_hi:[1,0]
  v_pk_fma_f32 v[70:71], v[68:69], v[68:69], v[70:71] op_sel:[1,1,0] op_sel_hi:[0,1,1] neg_lo:[1,0,0]
  v_pk_mul_f32 v[86:87], v[70:71], v[70:71] op_sel:[0,0] op_sel_hi:[1,0]
  v_pk_fma_f32 v[86:87], v[70:71], v[70:71], v[86:87] op_sel:[1,1,0] op_sel_hi:[0,1,1] neg_lo:[1,0,0]
  s_waitcnt lgkmcnt(0)
  v_cvt_pk_bf16_f32 v16, v74, v75
  v_mfma_f32_16x16x32_bf16 v[64:67], v[40:43], v[24:27], 0
  v_pk_mul_f32 v[22:23], v[74:75], v[70:71] op_sel:[0,0] op_sel_hi:[1,0]
  v_pk_fma_f32 v[22:23], v[74:75], v[70:71], v[22:23] op_sel:[1,1,0] op_sel_hi:[0,1,1] neg_lo:[1,0,0]
  v_cvt_pk_bf16_f32 v17, v22, v23
  ds_write2_b32 v6, v16, v17 offset0:0 offset1:72
  v_mfma_f32_16x16x32_bf16 v[64:67], v[44:47], v[28:31], v[64:67]
  v_pk_mul_f32 v[20:21], v[22:23], v[70:71] op_sel:[0,0] op_sel_hi:[1,0]
  v_pk_fma_f32 v[20:21], v[22:23], v[70:71], v[20:21] op_sel:[1,1,0] op_sel_hi:[0,1,1] neg_lo:[1,0,0]
  v_cvt_pk_bf16_f32 v18, v20, v21
  v_mfma_f32_16x16x32_bf16 v[64:67], v[48:51], v[32:35], v[64:67]
  v_pk_mul_f32 v[22:23], v[20:21], v[70:71] op_sel:[0,0] op_sel_hi:[1,0]
  v_pk_fma_f32 v[22:23], v[20:21], v[70:71], v[22:23] op_sel:[1,1,0] op_sel_hi:[0,1,1] neg_lo:[1,0,0]
  v_cvt_pk_bf16_f32 v13, v22, v23
  ds_write2_b32 v7, v18, v13 offset0:0 offset1:72
  v_mfma_f32_16x16x32_bf16 v[64:67], v[52:55], v[36:39], v[64:67]
  v_cvt_pk_bf16_f32 v16, v76, v77
  v_pk_mul_f32 v[22:23], v[76:77], v[70:71] op_sel:[0,0] op_sel_hi:[1,0]
  v_pk_fma_f32 v[22:23], v[76:77], v[70:71], v[22:23] op_sel:[1,1,0] op_sel_hi:[0,1,1] neg_lo:[1,0,0]
  v_cvt_pk_bf16_f32 v17, v22, v23
  ds_write2_b32 v8, v16, v17 offset0:0 offset1:72
  v_pk_mul_f32 v[20:21], v[22:23], v[70:71] op_sel:[0,0] op_sel_hi:[1,0]
  v_pk_fma_f32 v[20:21], v[22:23], v[70:71], v[20:21] op_sel:[1,1,0] op_sel_hi:[0,1,1] neg_lo:[1,0,0]
  v_cvt_pk_bf16_f32 v18, v20, v21
  v_pk_mul_f32 v[22:23], v[20:21], v[70:71] op_sel:[0,0] op_sel_hi:[1,0]
  v_pk_fma_f32 v[22:23], v[20:21], v[70:71], v[22:23] op_sel:[1,1,0] op_sel_hi:[0,1,1] neg_lo:[1,0,0]
  v_cvt_pk_bf16_f32 v13, v22, v23
  ds_write2_b32 v9, v18, v13 offset0:0 offset1:72
  v_cvt_pk_bf16_f32 v16, v78, v79
  v_pk_mul_f32 v[22:23], v[78:79], v[86:87] op_sel:[0,0] op_sel_hi:[1,0]
  v_pk_fma_f32 v[22:23], v[78:79], v[86:87], v[22:23] op_sel:[1,1,0] op_sel_hi:[0,1,1] neg_lo:[1,0,0]
  v_cvt_pk_bf16_f32 v17, v22, v23
  ds_write2_b32 v6, v16, v17 offset0:144 offset1:216
  v_cvt_pk_bf16_f32 v18, v80, v81
  v_pk_mul_f32 v[22:23], v[80:81], v[86:87] op_sel:[0,0] op_sel_hi:[1,0]
  v_pk_fma_f32 v[22:23], v[80:81], v[86:87], v[22:23] op_sel:[1,1,0] op_sel_hi:[0,1,1] neg_lo:[1,0,0]
  v_cvt_pk_bf16_f32 v13, v22, v23
  ds_write2_b32 v7, v18, v13 offset0:144 offset1:216
  v_cvt_pk_bf16_f32 v16, v82, v83
  v_pk_mul_f32 v[22:23], v[82:83], v[86:87] op_sel:[0,0] op_sel_hi:[1,0]
  v_pk_fma_f32 v[22:23], v[82:83], v[86:87], v[22:23] op_sel:[1,1,0] op_sel_hi:[0,1,1] neg_lo:[1,0,0]
  v_cvt_pk_bf16_f32 v17, v22, v23
  ds_write2_b32 v8, v16, v17 offset0:144 offset1:216
  v_cvt_pk_bf16_f32 v18, v84, v85
  v_pk_mul_f32 v[22:23], v[84:85], v[86:87] op_sel:[0,0] op_sel_hi:[1,0]
  v_pk_fma_f32 v[22:23], v[84:85], v[86:87], v[22:23] op_sel:[1,1,0] op_sel_hi:[0,1,1] neg_lo:[1,0,0]
  v_cvt_pk_bf16_f32 v13, v22, v23
  ds_write2_b32 v9, v18, v13 offset0:144 offset1:216
  ds_read_b128 v[40:43], v10 offset:0
  ds_read_b128 v[44:47], v10 offset:64
  ds_read_b128 v[48:51], v10 offset:128
  ds_read_b128 v[52:55], v10 offset:192
  v_pk_mul_f32 v[88:89], v[14:15], v[68:69] op_sel:[0,0] op_sel_hi:[1,0]
  v_pk_fma_f32 v[88:89], v[14:15], v[68:69], v[88:89] op_sel:[1,1,0] op_sel_hi:[0,1,1] neg_lo:[1,0,0]
  v_pk_mul_f32 v[90:91], v[88:89], v[68:69] op_sel:[0,0] op_sel_hi:[1,0]
  v_pk_fma_f32 v[90:91], v[88:89], v[68:69], v[90:91] op_sel:[1,1,0] op_sel_hi:[0,1,1] neg_lo:[1,0,0]
  s_waitcnt lgkmcnt(0)
  v_cvt_pk_bf16_f32 v16, v14, v15
  v_mfma_f32_16x16x32_bf16 v[60:63], v[40:43], v[24:27], 0
  v_cvt_pk_bf16_f32 v17, v88, v89
  ds_write2_b32 v6, v16, v17 offset0:0 offset1:72
  v_mfma_f32_16x16x32_bf16 v[60:63], v[44:47], v[28:31], v[60:63]
  v_cvt_pk_bf16_f32 v18, v90, v91
  v_mfma_f32_16x16x32_bf16 v[60:63], v[48:51], v[32:35], v[60:63]
  v_pk_mul_f32 v[22:23], v[90:91], v[68:69] op_sel:[0,0] op_sel_hi:[1,0]
  v_pk_fma_f32 v[22:23], v[90:91], v[68:69], v[22:23] op_sel:[1,1,0] op_sel_hi:[0,1,1] neg_lo:[1,0,0]
  v_cvt_pk_bf16_f32 v13, v22, v23
  ds_write2_b32 v6, v18, v13 offset0:144 offset1:216
  v_mfma_f32_16x16x32_bf16 v[60:63], v[52:55], v[36:39], v[60:63]
  v_pk_mul_f32 v[20:21], v[22:23], v[68:69] op_sel:[0,0] op_sel_hi:[1,0]
  v_pk_fma_f32 v[20:21], v[22:23], v[68:69], v[20:21] op_sel:[1,1,0] op_sel_hi:[0,1,1] neg_lo:[1,0,0]
  v_cvt_pk_bf16_f32 v16, v20, v21
  v_pk_mul_f32 v[22:23], v[20:21], v[68:69] op_sel:[0,0] op_sel_hi:[1,0]
  v_pk_fma_f32 v[22:23], v[20:21], v[68:69], v[22:23] op_sel:[1,1,0] op_sel_hi:[0,1,1] neg_lo:[1,0,0]
  v_cvt_pk_bf16_f32 v17, v22, v23
  ds_write2_b32 v7, v16, v17 offset0:0 offset1:72
  v_pk_mul_f32 v[20:21], v[22:23], v[68:69] op_sel:[0,0] op_sel_hi:[1,0]
  v_pk_fma_f32 v[20:21], v[22:23], v[68:69], v[20:21] op_sel:[1,1,0] op_sel_hi:[0,1,1] neg_lo:[1,0,0]
  v_cvt_pk_bf16_f32 v18, v20, v21
  v_pk_mul_f32 v[22:23], v[20:21], v[68:69] op_sel:[0,0] op_sel_hi:[1,0]
  v_pk_fma_f32 v[22:23], v[20:21], v[68:69], v[22:23] op_sel:[1,1,0] op_sel_hi:[0,1,1] neg_lo:[1,0,0]
  v_cvt_pk_bf16_f32 v13, v22, v23
  ds_write2_b32 v7, v18, v13 offset0:144 offset1:216
  v_cvt_pk_bf16_f32 v16, v72, v73
  v_pk_mul_f32 v[22:23], v[72:73], v[68:69] op_sel:[0,0] op_sel_hi:[1,0]
  v_pk_fma_f32 v[22:23], v[72:73], v[68:69], v[22:23] op_sel:[1,1,0] op_sel_hi:[0,1,1] neg_lo:[1,0,0]
  v_cvt_pk_bf16_f32 v17, v22, v23
  ds_write2_b32 v8, v16, v17 offset0:0 offset1:72
  v_pk_mul_f32 v[20:21], v[22:23], v[68:69] op_sel:[0,0] op_sel_hi:[1,0]
  v_pk_fma_f32 v[20:21], v[22:23], v[68:69], v[20:21] op_sel:[1,1,0] op_sel_hi:[0,1,1] neg_lo:[1,0,0]
  v_cvt_pk_bf16_f32 v18, v20, v21
  v_pk_mul_f32 v[22:23], v[20:21], v[68:69] op_sel:[0,0] op_sel_hi:[1,0]
  v_pk_fma_f32 v[22:23], v[20:21], v[68:69], v[22:23] op_sel:[1,1,0] op_sel_hi:[0,1,1] neg_lo:[1,0,0]
  v_cvt_pk_bf16_f32 v13, v22, v23
  ds_write2_b32 v8, v18, v13 offset0:144 offset1:216
  v_pk_mul_f32 v[20:21], v[22:23], v[68:69] op_sel:[0,0] op_sel_hi:[1,0]
  v_pk_fma_f32 v[20:21], v[22:23], v[68:69], v[20:21] op_sel:[1,1,0] op_sel_hi:[0,1,1] neg_lo:[1,0,0]
  v_cvt_pk_bf16_f32 v16, v20, v21
  v_pk_mul_f32 v[22:23], v[20:21], v[68:69] op_sel:[0,0] op_sel_hi:[1,0]
  v_pk_fma_f32 v[22:23], v[20:21], v[68:69], v[22:23] op_sel:[1,1,0] op_sel_hi:[0,1,1] neg_lo:[1,0,0]
  v_cvt_pk_bf16_f32 v17, v22, v23
  ds_write2_b32 v9, v16, v17 offset0:0 offset1:72
  v_pk_mul_f32 v[20:21], v[22:23], v[68:69] op_sel:[0,0] op_sel_hi:[1,0]
  v_pk_fma_f32 v[20:21], v[22:23], v[68:69], v[20:21] op_sel:[1,1,0] op_sel_hi:[0,1,1] neg_lo:[1,0,0]
  v_cvt_pk_bf16_f32 v18, v20, v21
  v_pk_mul_f32 v[22:23], v[20:21], v[68:69] op_sel:[0,0] op_sel_hi:[1,0]
  v_pk_fma_f32 v[22:23], v[20:21], v[68:69], v[22:23] op_sel:[1,1,0] op_sel_hi:[0,1,1] neg_lo:[1,0,0]
  v_cvt_pk_bf16_f32 v13, v22, v23
  ds_write2_b32 v9, v18, v13 offset0:144 offset1:216
  ds_read_b128 v[40:43], v10 offset:0
  ds_read_b128 v[44:47], v10 offset:64
  ds_read_b128 v[48:51], v10 offset:128
  ds_read_b128 v[52:55], v10 offset:192
  v_lshrrev_b32 v2, 1, v5
  v_lshlrev_b32 v2, 8, v2
  v_and_b32 v3, 1, v5
  v_lshl_add_u32 v2, v3, 3, v2
  v_lshl_add_u32 v2, v4, 4, v2
  v_sub_u32 v2, s94, v2
  v_add_u32 v19, 4088, v2
  v_add_u32 v95, 3578, v2
  v_lshlrev_b32 v2, 9, v5
  v_lshl_add_u32 v2, v4, 4, v2
  v_sub_u32 v92, s94, v2
  v_add_u32 v92, 1784, v92
  v_and_b32 v3, 1, v4
  v_lshl_add_u32 v93, v3, 1, v92
  v_subrev_u32 v93, 2, v93
  v_lshlrev_b32 v2, 8, v5
  v_lshl_add_u32 v2, v4, 4, v2
  v_sub_u32 v94, s94, v2
  v_add_u32 v94, 3060, v94
  v_cmp_eq_u32 vcc, 0, v1
  v_add_u32 v96, 6, v95
  v_add_u32 v2, 2, v95
  v_cndmask_b32 v96, v96, v2, vcc
  s_waitcnt lgkmcnt(0)
  v_mfma_f32_16x16x32_bf16 v[56:59], v[40:43], v[24:27], 0
  v_mfma_f32_16x16x32_bf16 v[56:59], v[44:47], v[28:31], v[56:59]
  v_mfma_f32_16x16x32_bf16 v[56:59], v[48:51], v[32:35], v[56:59]
  v_mfma_f32_16x16x32_bf16 v[56:59], v[52:55], v[36:39], v[56:59]
  s_cmp_eq_u32 s98, 1
  s_nop 6
  s_cbranch_scc1 L_k_h1_5
  ds_write_b128 v11, v[60:63]
  ds_write_b128 v11, v[64:67] offset:1024
  s_waitcnt lgkmcnt(0)
  s_barrier
  ds_read_b128 v[40:43], v12
  s_waitcnt lgkmcnt(0)
  v_pk_add_f32 v[40:41], v[40:41], v[56:57]
  v_pk_add_f32 v[42:43], v[42:43], v[58:59]
  v_cvt_pk_bf16_f32 v44, v43, v42
  v_cvt_pk_bf16_f32 v45, v41, v40
  ds_write_b64 v19, v[44:45]
  s_branch L_k_j_6
L_k_h1_5:
  ds_write_b128 v11, v[56:59]
  s_waitcnt lgkmcnt(0)
  s_barrier
  ds_read_b128 v[40:43], v12
  ds_read_b128 v[44:47], v12 offset:1024
  s_waitcnt lgkmcnt(0)
  v_pk_add_f32 v[40:41], v[40:41], v[60:61]
  v_pk_add_f32 v[44:45], v[44:45], v[64:65]
  v_pk_add_f32 v[42:43], v[42:43], v[62:63]
  v_pk_add_f32 v[46:47], v[46:47], v[66:67]
  v_cvt_pk_bf16_f32 v48, v44, v44
  v_mov_b32 v49, v48
  v_cvt_pk_bf16_f32 v50, v45, v45
  v_mov_b32 v51, v50
  v_cvt_pk_bf16_f32 v52, v46, v46
  v_mov_b32 v53, v52
  ds_write2_b64 v92, v[48:49], v[48:49] offset0:32 offset1:33
  ds_write2_b64 v92, v[50:51], v[50:51] offset0:0 offset1:1
  v_mov_b32 v2, s94
  s_mov_b64 exec, 1
  ds_write_b64 v2, v[52:53]
  s_mov_b64 exec, -1
  ds_write_b16 v93, v48 offset:256
  ds_write_b16 v93, v50
  v_cvt_pk_bf16_f32 v24, v43, v43
  v_cvt_pk_bf16_f32 v25, v43, v42
  v_cvt_pk_bf16_f32 v26, v42, v42
  ds_write2_b32 v94, v24, v25 offset0:0 offset1:1
  ds_write2_b32 v94, v26, v26 offset0:2 offset1:3
  v_cvt_pk_bf16_f32 v28, v41, v41
  v_cvt_pk_bf16_f32 v29, v40, v40
  ds_write_b16 v95, v28
  ds_write_b32 v95, v29 offset:2
  ds_write_b16 v96, v29
L_k_j_6:
  v_mov_b32 v3, 0
  v_min_u32 v2, 7, v1
  v_lshl_add_u32 v2, v2, 2, s96
  ds_write_b32 v2, v3 offset:0
  v_min_u32 v2, 6, v1
  v_lshl_add_u32 v2, v2, 2, s96
  ds_write_b32 v2, v3 offset:4164
  s_waitcnt lgkmcnt(0)
  s_add_u32 m0, s35, 0
  s_nop 0
  buffer_load_dwordx4 v152, s[8:11], s37 offen lds
  s_add_u32 m0, s35, 1024
  s_nop 0
  buffer_load_dwordx4 v153, s[8:11], s37 offen lds
  s_add_u32 s37, s37, 64
  s_add_u32 m0, s36, 0
  s_nop 0
  buffer_load_dwordx4 v154, s[12:15], s38 offen lds
  s_add_u32 m0, s36, 1024
  s_nop 0
  buffer_load_dwordx4 v155, s[12:15], s38 offen lds
  s_add_u32 m0, s36, 2048
  s_mov_b64 exec, 0xffffffff
  buffer_load_dwordx4 v156, s[12:15], s38 offen lds
  s_mov_b64 exec, -1
  s_add_u32 s38, s38, 122880
  s_add_u32 m0, s35, 18432
  s_nop 0
  buffer_load_dwordx4 v152, s[8:11], s37 offen lds
  s_add_u32 m0, s35, 19456
  s_nop 0
  buffer_load_dwordx4 v153, s[8:11], s37 offen lds
  s_add_u32 s37, s37, 64
  s_add_u32 m0, s36, 18432
  s_nop 0
  buffer_load_dwordx4 v154, s[12:15], s38 offen lds
  s_add_u32 m0, s36, 19456
  s_nop 0
  buffer_load_dwordx4 v155, s[12:15], s38 offen lds
  s_add_u32 m0, s36, 20480
  s_mov_b64 exec, 0xffffffff
  buffer_load_dwordx4 v156, s[12:15], s38 offen lds
  s_mov_b64 exec, -1
  s_add_u32 s38, s38, 122880
  s_add_u32 m0, s35, 36864
  s_nop 0
  buffer_load_dwordx4 v152, s[8:11], s37 offen lds
  s_add_u32 m0, s35, 37888
  s_nop 0
  buffer_load_dwordx4 v153, s[8:11], s37 offen lds
  s_add_u32 s37, s37, 64
  s_add_u32 m0, s36, 36864
  s_nop 0
  buffer_load_dwordx4 v154, s[12:15], s38 offen lds
  s_add_u32 m0, s36, 37888
  s_nop 0
  buffer_load_dwordx4 v155, s[12:15], s38 offen lds
  s_add_u32 m0, s36, 38912
  s_mov_b64 exec, 0xffffffff
  buffer_load_dwordx4 v156, s[12:15], s38 offen lds
  s_mov_b64 exec, -1
  s_add_u32 s38, s38, 122880
  v_mov_b32 v0, 0
  v_mov_b32 v1, 0
  v_mov_b32 v2, 0
  v_mov_b32 v3, 0
  v_mov_b32 v4, 0
  v_mov_b32 v5, 0
  v_mov_b32 v6, 0
  v_mov_b32 v7, 0
  v_mov_b32 v8, 0
  v_mov_b32 v9, 0
  v_mov_b32 v10, 0
  v_mov_b32 v11, 0
  v_mov_b32 v12, 0
  v_mov_b32 v13, 0
  v_mov_b32 v14, 0
  v_mov_b32 v15, 0
  v_mov_b32 v16, 0
  v_mov_b32 v17, 0
  v_mov_b32 v18, 0
  v_mov_b32 v19, 0
  v_mov_b32 v20, 0
  v_mov_b32 v21, 0
  v_mov_b32 v22, 0
  v_mov_b32 v23, 0
  v_mov_b32 v24, 0
  v_mov_b32 v25, 0
  v_mov_b32 v26, 0
  v_mov_b32 v27, 0
  v_mov_b32 v28, 0
  v_mov_b32 v29, 0
  v_mov_b32 v30, 0
  v_mov_b32 v31, 0
  v_mov_b32 v32, 0
  v_mov_b32 v33, 0
  v_mov_b32 v34, 0
  v_mov_b32 v35, 0
  v_mov_b32 v36, 0
  v_mov_b32 v37, 0
  v_mov_b32 v38, 0
  v_mov_b32 v39, 0
  v_mov_b32 v40, 0
  v_mov_b32 v41, 0
  v_mov_b32 v42, 0
  v_mov_b32 v43, 0
  v_mov_b32 v44, 0
  v_mov_b32 v45, 0
  v_mov_b32 v46, 0
  v_mov_b32 v47, 0
  v_mov_b32 v48, 0
  v_mov_b32 v49, 0
  v_mov_b32 v50, 0
  v_mov_b32 v51, 0
  v_mov_b32 v52, 0
  v_mov_b32 v53, 0
  v_mov_b32 v54, 0
  v_mov_b32 v55, 0
  v_mov_b32 v56, 0
  v_mov_b32 v57, 0
  v_mov_b32 v58, 0
  v_mov_b32 v59, 0
  v_mov_b32 v60, 0
  v_mov_b32 v61, 0
  v_mov_b32 v62, 0
  v_mov_b32 v63, 0
  v_mov_b32 v64, 0
  v_mov_b32 v65, 0
  v_mov_b32 v66, 0
  v_mov_b32 v67, 0
  v_mov_b32 v68, 0
  v_mov_b32 v69, 0
  v_mov_b32 v70, 0
  v_mov_b32 v71, 0
  v_mov_b32 v72, 0
  v_mov_b32 v73, 0
  v_mov_b32 v74, 0
  v_mov_b32 v75, 0
  v_mov_b32 v76, 0
  v_mov_b32 v77, 0
  v_mov_b32 v78, 0
  v_mov_b32 v79, 0
  s_setprio 3
  s_mov_b32 s41, 0
  s_waitcnt vmcnt(10)
  s_barrier
  ds_read_b128 v[80:83], v159 offset:0
  ds_read_b128 v[84:87], v159 offset:1024
  ds_read_b128 v[88:91], v159 offset:2048
  ds_read_b128 v[92:95], v159 offset:3072
  ds_read_b64_tr_b16 v[96:97], v157 offset:8192
  ds_read_b64_tr_b16 v[98:99], v157 offset:9472
  ds_read_b64_tr_b16 v[100:101], v158 offset:8224
  ds_read_b64_tr_b16 v[102:103], v158 offset:9504
  ds_read_b64_tr_b16 v[104:105], v157 offset:8256
  ds_read_b64_tr_b16 v[106:107], v157 offset:9536
  ds_read_b64_tr_b16 v[108:109], v158 offset:8288
  ds_read_b64_tr_b16 v[110:111], v158 offset:9568
  ds_read_b64_tr_b16 v[112:113], v157 offset:8320
  ds_read_b64_tr_b16 v[114:115], v157 offset:9600
  s_cmp_ge_u32 s4, 8
  s_cbranch_scc1 L_g_q_7
L_g_loop_9:
  s_waitcnt vmcnt(5)
  s_barrier
  s_waitcnt lgkmcnt(0)
  v_mfma_f32_16x16x32_bf16 v[0:3], v[80:83], v[96:99], v[0:3]
  ds_read_b128 v[116:119], v159 offset:18432
  v_mfma_f32_16x16x32_bf16 v[4:7], v[84:87], v[96:99], v[4:7]
  ds_read_b128 v[120:123], v159 offset:19456
  v_mfma_f32_16x16x32_bf16 v[8:11], v[88:91], v[96:99], v[8:11]
  ds_read_b64_tr_b16 v[132:133], v157 offset:26624
  ds_read_b64_tr_b16 v[134:135], v157 offset:27904
  v_mfma_f32_16x16x32_bf16 v[12:15], v[92:95], v[96:99], v[12:15]
  s_add_u32 m0, s35, 55296
  s_nop 0
  buffer_load_dwordx4 v152, s[8:11], s37 offen lds
  v_mfma_f32_16x16x32_bf16 v[16:19], v[80:83], v[100:103], v[16:19]
  ds_read_b128 v[124:127], v159 offset:20480
  v_mfma_f32_16x16x32_bf16 v[20:23], v[84:87], v[100:103], v[20:23]
  ds_read_b128 v[128:131], v159 offset:21504
  v_mfma_f32_16x16x32_bf16 v[24:27], v[88:91], v[100:103], v[24:27]
  ds_read_b64_tr_b16 v[136:137], v158 offset:26656
  ds_read_b64_tr_b16 v[138:139], v158 offset:27936
  v_mfma_f32_16x16x32_bf16 v[28:31], v[92:95], v[100:103], v[28:31]
  s_add_u32 m0, s36, 55296
  s_nop 0
  buffer_load_dwordx4 v154, s[12:15], s38 offen lds
  v_mfma_f32_16x16x32_bf16 v[32:35], v[80:83], v[104:107], v[32:35]
  ds_read_b64_tr_b16 v[140:141], v157 offset:26688
  ds_read_b64_tr_b16 v[142:143], v157 offset:27968
  v_mfma_f32_16x16x32_bf16 v[36:39], v[84:87], v[104:107], v[36:39]
  s_add_u32 m0, s35, 56320
  s_nop 0
  buffer_load_dwordx4 v153, s[8:11], s37 offen lds
  s_add_u32 s37, s37, 64
  v_mfma_f32_16x16x32_bf16 v[40:43], v[88:91], v[104:107], v[40:43]
  ds_read_b64_tr_b16 v[144:145], v158 offset:26720
  ds_read_b64_tr_b16 v[146:147], v158 offset:28000
  v_mfma_f32_16x16x32_bf16 v[44:47], v[92:95], v[104:107], v[44:47]
  s_add_u32 m0, s36, 56320
  s_nop 0
  buffer_load_dwordx4 v155, s[12:15], s38 offen lds
  v_mfma_f32_16x16x32_bf16 v[48:51], v[80:83], v[108:111], v[48:51]
  ds_read_b64_tr_b16 v[148:149], v157 offset:26752
  ds_read_b64_tr_b16 v[150:151], v157 offset:28032
  v_mfma_f32_16x16x32_bf16 v[52:55], v[84:87], v[108:111], v[52:55]
  v_mfma_f32_16x16x32_bf16 v[56:59], v[88:91], v[108:111], v[56:59]
  s_add_u32 m0, s36, 57344
  s_mov_b64 exec, 0xffffffff
  buffer_load_dwordx4 v156, s[12:15], s38 offen lds
  s_mov_b64 exec, -1
  s_add_u32 s38, s38, 122880
  v_mfma_f32_16x16x32_bf16 v[60:63], v[92:95], v[108:111], v[60:63]
  v_mfma_f32_16x16x32_bf16 v[64:67], v[80:83], v[112:115], v[64:67]
  v_mfma_f32_16x16x32_bf16 v[68:71], v[84:87], v[112:115], v[68:71]
  v_mfma_f32_16x16x32_bf16 v[72:75], v[88:91], v[112:115], v[72:75]
  v_mfma_f32_16x16x32_bf16 v[76:79], v[92:95], v[112:115], v[76:79]
  s_waitcnt vmcnt(5)
  s_barrier
  s_waitcnt lgkmcnt(0)
  v_mfma_f32_16x16x32_bf16 v[0:3], v[116:119], v[132:135], v[0:3]
  ds_read_b128 v[80:83], v159 offset:36864
  v_mfma_f32_16x16x32_bf16 v[4:7], v[120:123], v[132:135], v[4:7]
  ds_read_b128 v[84:87], v159 offset:37888
  v_mfma_f32_16x16x32_bf16 v[8:11], v[124:127], v[132:135], v[8:11]
  ds_read_b64_tr_b16 v[96:97], v157 offset:45056
  ds_read_b64_tr_b16 v[98:99], v157 offset:46336
  v_mfma_f32_16x16x32_bf16 v[12:15], v[128:131], v[132:135], v[12:15]
  s_add_u32 m0, s35, 0
  s_nop 0
  buffer_load_dwordx4 v152, s[8:11], s37 offen lds
  v_mfma_f32_16x16x32_bf16 v[16:19], v[116:119], v[136:139], v[16:19]
  ds_read_b128 v[88:91], v159 offset:38912
  v_mfma_f32_16x16x32_bf16 v[20:23], v[120:123], v[136:139], v[20:23]
  ds_read_b128 v[92:95], v159 offset:39936
  v_mfma_f32_16x16x32_bf16 v[24:27], v[124:127], v[136:139], v[24:27]
  ds_read_b64_tr_b16 v[100:101], v158 offset:45088
  ds_read_b64_tr_b16 v[102:103], v158 offset:46368
  v_mfma_f32_16x16x32_bf16 v[28:31], v[128:131], v[136:139], v[28:31]
  s_add_u32 m0, s36, 0
  s_nop 0
  buffer_load_dwordx4 v154, s[12:15], s38 offen lds
  v_mfma_f32_16x16x32_bf16 v[32:35], v[116:119], v[140:143], v[32:35]
  ds_read_b64_tr_b16 v[104:105], v157 offset:45120
  ds_read_b64_tr_b16 v[106:107], v157 offset:46400
  v_mfma_f32_16x16x32_bf16 v[36:39], v[120:123], v[140:143], v[36:39]
  s_add_u32 m0, s35, 1024
  s_nop 0
  buffer_load_dwordx4 v153, s[8:11], s37 offen lds
  s_add_u32 s37, s37, 64
  v_mfma_f32_16x16x32_bf16 v[40:43], v[124:127], v[140:143], v[40:43]
  ds_read_b64_tr_b16 v[108:109], v158 offset:45152
  ds_read_b64_tr_b16 v[110:111], v158 offset:46432
  v_mfma_f32_16x16x32_bf16 v[44:47], v[128:131], v[140:143], v[44:47]
  s_add_u32 m0, s36, 1024
  s_nop 0
  buffer_load_dwordx4 v155, s[12:15], s38 offen lds
  v_mfma_f32_16x16x32_bf16 v[48:51], v[116:119], v[144:147], v[48:51]
  ds_read_b64_tr_b16 v[112:113], v157 offset:45184
  ds_read_b64_tr_b16 v[114:115], v157 offset:46464
  v_mfma_f32_16x16x32_bf16 v[52:55], v[120:123], v[144:147], v[52:55]
  v_mfma_f32_16x16x32_bf16 v[56:59], v[124:127], v[144:147], v[56:59]
  s_add_u32 m0, s36, 2048
  s_mov_b64 exec, 0xffffffff
  buffer_load_dwordx4 v156, s[12:15], s38 offen lds
  s_mov_b64 exec, -1
  s_add_u32 s38, s38, 122880
  v_mfma_f32_16x16x32_bf16 v[60:63], v[128:131], v[144:147], v[60:63]
  v_mfma_f32_16x16x32_bf16 v[64:67], v[116:119], v[148:151], v[64:67]
  v_mfma_f32_16x16x32_bf16 v[68:71], v[120:123], v[148:151], v[68:71]
  v_mfma_f32_16x16x32_bf16 v[72:75], v[124:127], v[148:151], v[72:75]
  v_mfma_f32_16x16x32_bf16 v[76:79], v[128:131], v[148:151], v[76:79]
  s_waitcnt vmcnt(5)
  s_barrier
  s_waitcnt lgkmcnt(0)
  v_mfma_f32_16x16x32_bf16 v[0:3], v[80:83], v[96:99], v[0:3]
  ds_read_b128 v[116:119], v159 offset:55296
  v_mfma_f32_16x16x32_bf16 v[4:7], v[84:87], v[96:99], v[4:7]
  ds_read_b128 v[120:123], v159 offset:56320
  v_mfma_f32_16x16x32_bf16 v[8:11], v[88:91], v[96:99], v[8:11]
  ds_read_b64_tr_b16 v[132:133], v157 offset:63488
  ds_read_b64_tr_b16 v[134:135], v157 offset:64768
  v_mfma_f32_16x16x32_bf16 v[12:15], v[92:95], v[96:99], v[12:15]
  s_add_u32 m0, s35, 18432
  s_nop 0
  buffer_load_dwordx4 v152, s[8:11], s37 offen lds
  v_mfma_f32_16x16x32_bf16 v[16:19], v[80:83], v[100:103], v[16:19]
  ds_read_b128 v[124:127], v159 offset:57344
  v_mfma_f32_16x16x32_bf16 v[20:23], v[84:87], v[100:103], v[20:23]
  ds_read_b128 v[128:131], v159 offset:58368
  v_mfma_f32_16x16x32_bf16 v[24:27], v[88:91], v[100:103], v[24:27]
  ds_read_b64_tr_b16 v[136:137], v158 offset:63520
  ds_read_b64_tr_b16 v[138:139], v158 offset:64800
  v_mfma_f32_16x16x32_bf16 v[28:31], v[92:95], v[100:103], v[28:31]
  s_add_u32 m0, s36, 18432
  s_nop 0
  buffer_load_dwordx4 v154, s[12:15], s38 offen lds
  v_mfma_f32_16x16x32_bf16 v[32:35], v[80:83], v[104:107], v[32:35]
  ds_read_b64_tr_b16 v[140:141], v157 offset:63552
  ds_read_b64_tr_b16 v[142:143], v157 offset:64832
  v_mfma_f32_16x16x32_bf16 v[36:39], v[84:87], v[104:107], v[36:39]
  s_add_u32 m0, s35, 19456
  s_nop 0
  buffer_load_dwordx4 v153, s[8:11], s37 offen lds
  s_add_u32 s37, s37, 64
  v_mfma_f32_16x16x32_bf16 v[40:43], v[88:91], v[104:107], v[40:43]
  ds_read_b64_tr_b16 v[144:145], v158 offset:63584
  ds_read_b64_tr_b16 v[146:147], v158 offset:64864
  v_mfma_f32_16x16x32_bf16 v[44:47], v[92:95], v[104:107], v[44:47]
  s_add_u32 m0, s36, 19456
  s_nop 0
  buffer_load_dwordx4 v155, s[12:15], s38 offen lds
  v_mfma_f32_16x16x32_bf16 v[48:51], v[80:83], v[108:111], v[48:51]
  ds_read_b64_tr_b16 v[148:149], v157 offset:63616
  ds_read_b64_tr_b16 v[150:151], v157 offset:64896
  v_mfma_f32_16x16x32_bf16 v[52:55], v[84:87], v[108:111], v[52:55]
  v_mfma_f32_16x16x32_bf16 v[56:59], v[88:91], v[108:111], v[56:59]
  s_add_u32 m0, s36, 20480
  s_mov_b64 exec, 0xffffffff
  buffer_load_dwordx4 v156, s[12:15], s38 offen lds
  s_mov_b64 exec, -1
  s_add_u32 s38, s38, 122880
  v_mfma_f32_16x16x32_bf16 v[60:63], v[92:95], v[108:111], v[60:63]
  v_mfma_f32_16x16x32_bf16 v[64:67], v[80:83], v[112:115], v[64:67]
  v_mfma_f32_16x16x32_bf16 v[68:71], v[84:87], v[112:115], v[68:71]
  v_mfma_f32_16x16x32_bf16 v[72:75], v[88:91], v[112:115], v[72:75]
  v_mfma_f32_16x16x32_bf16 v[76:79], v[92:95], v[112:115], v[76:79]
  s_waitcnt vmcnt(5)
  s_barrier
  s_waitcnt lgkmcnt(0)
  v_mfma_f32_16x16x32_bf16 v[0:3], v[116:119], v[132:135], v[0:3]
  ds_read_b128 v[80:83], v159 offset:0
  v_mfma_f32_16x16x32_bf16 v[4:7], v[120:123], v[132:135], v[4:7]
  ds_read_b128 v[84:87], v159 offset:1024
  v_mfma_f32_16x16x32_bf16 v[8:11], v[124:127], v[132:135], v[8:11]
  ds_read_b64_tr_b16 v[96:97], v157 offset:8192
  ds_read_b64_tr_b16 v[98:99], v157 offset:9472
  v_mfma_f32_16x16x32_bf16 v[12:15], v[128:131], v[132:135], v[12:15]
  s_add_u32 m0, s35, 36864
  s_nop 0
  buffer_load_dwordx4 v152, s[8:11], s37 offen lds
  v_mfma_f32_16x16x32_bf16 v[16:19], v[116:119], v[136:139], v[16:19]
  ds_read_b128 v[88:91], v159 offset:2048
  v_mfma_f32_16x16x32_bf16 v[20:23], v[120:123], v[136:139], v[20:23]
  ds_read_b128 v[92:95], v159 offset:3072
  v_mfma_f32_16x16x32_bf16 v[24:27], v[124:127], v[136:139], v[24:27]
  ds_read_b64_tr_b16 v[100:101], v158 offset:8224
  ds_read_b64_tr_b16 v[102:103], v158 offset:9504
  v_mfma_f32_16x16x32_bf16 v[28:31], v[128:131], v[136:139], v[28:31]
  s_add_u32 m0, s36, 36864
  s_nop 0
  buffer_load_dwordx4 v154, s[12:15], s38 offen lds
  v_mfma_f32_16x16x32_bf16 v[32:35], v[116:119], v[140:143], v[32:35]
  ds_read_b64_tr_b16 v[104:105], v157 offset:8256
  ds_read_b64_tr_b16 v[106:107], v157 offset:9536
  v_mfma_f32_16x16x32_bf16 v[36:39], v[120:123], v[140:143], v[36:39]
  s_add_u32 m0, s35, 37888
  s_nop 0
  buffer_load_dwordx4 v153, s[8:11], s37 offen lds
  s_add_u32 s37, s37, 64
  v_mfma_f32_16x16x32_bf16 v[40:43], v[124:127], v[140:143], v[40:43]
  ds_read_b64_tr_b16 v[108:109], v158 offset:8288
  ds_read_b64_tr_b16 v[110:111], v158 offset:9568
  v_mfma_f32_16x16x32_bf16 v[44:47], v[128:131], v[140:143], v[44:47]
  s_add_u32 m0, s36, 37888
  s_nop 0
  buffer_load_dwordx4 v155, s[12:15], s38 offen lds
  v_mfma_f32_16x16x32_bf16 v[48:51], v[116:119], v[144:147], v[48:51]
  ds_read_b64_tr_b16 v[112:113], v157 offset:8320
  ds_read_b64_tr_b16 v[114:115], v157 offset:9600
  v_mfma_f32_16x16x32_bf16 v[52:55], v[120:123], v[144:147], v[52:55]
  v_mfma_f32_16x16x32_bf16 v[56:59], v[124:127], v[144:147], v[56:59]
  s_add_u32 m0, s36, 38912
  s_mov_b64 exec, 0xffffffff
  buffer_load_dwordx4 v156, s[12:15], s38 offen lds
  s_mov_b64 exec, -1
  s_add_u32 s38, s38, 122880
  v_mfma_f32_16x16x32_bf16 v[60:63], v[128:131], v[144:147], v[60:63]
  v_mfma_f32_16x16x32_bf16 v[64:67], v[116:119], v[148:151], v[64:67]
  v_mfma_f32_16x16x32_bf16 v[68:71], v[120:123], v[148:151], v[68:71]
  v_mfma_f32_16x16x32_bf16 v[72:75], v[124:127], v[148:151], v[72:75]
  v_mfma_f32_16x16x32_bf16 v[76:79], v[128:131], v[148:151], v[76:79]
  s_add_u32 s41, s41, 1
  s_cmp_lt_u32 s41, 5
  s_cbranch_scc1 L_g_loop_9
  s_nop 4
  s_mov_b32 s56, 1069066811
  s_mov_b32 s57, 1069066811
  s_mov_b32 s58, 897988541
  s_mov_b32 s59, 897988541
  s_waitcnt lgkmcnt(0)
  v_mbcnt_lo_u32_b32 v152, -1, 0
  v_mbcnt_hi_u32_b32 v152, -1, v152
  v_and_b32 v153, 15, v152
  v_lshrrev_b32 v154, 4, v152
  s_waitcnt vmcnt(0)
  v_mbcnt_lo_u32_b32 v174, -1, 0
  v_mbcnt_hi_u32_b32 v174, -1, v174
  s_mul_i32 s100, s90, 820
  s_lshr_b32 s100, s100, 16
  s_lshl_b32 s100, s100, 6
  s_add_u32 s100, s100, 8126464
  v_and_b32 v169, 15, v174
  v_lshl_add_u32 v169, v169, 2, s100
  v_mov_b32 v171, 0
  global_load_dword v172, v171, s[48:49] sc1
  global_load_dword v170, v169, s[50:51] sc1
  s_lshl_b32 s100, s98, 6
  v_add_u32 v174, s100, v174
  s_lshl_b32 s100, s99, 12
  s_add_u32 s100, s100, 2621440
  v_lshl_add_u32 v173, v174, 5, s100
  s_barrier
  s_mul_i32 s34, s53, 20480
  v_lshl_add_u32 v155, v152, 4, s34
  v_mov_b32 v130, 4
  global_load_dword v131, v130, s[48:49] sc1
  s_cmp_eq_u32 s54, 1
  s_cbranch_scc1 L_g_wc1_10
  v_cvt_pk_bf16_f32 v80, v64, v65
  v_cvt_pk_bf16_f32 v81, v66, v67
  v_cvt_pk_bf16_f32 v82, v68, v69
  v_cvt_pk_bf16_f32 v83, v70, v71
  ds_write_b128 v155, v[80:83] offset:6144
  v_cvt_pk_bf16_f32 v84, v72, v73
  v_cvt_pk_bf16_f32 v85, v74, v75
  v_cvt_pk_bf16_f32 v86, v76, v77
  v_cvt_pk_bf16_f32 v87, v78, v79
  ds_write_b128 v155, v[84:87] offset:16384
  v_cvt_pk_bf16_f32 v88, v48, v49
  v_cvt_pk_bf16_f32 v89, v50, v51
  v_cvt_pk_bf16_f32 v90, v52, v53
  v_cvt_pk_bf16_f32 v91, v54, v55
  ds_write_b128 v155, v[88:91] offset:5120
  v_cvt_pk_bf16_f32 v92, v56, v57
  v_cvt_pk_bf16_f32 v93, v58, v59
  v_cvt_pk_bf16_f32 v94, v60, v61
  v_cvt_pk_bf16_f32 v95, v62, v63
  ds_write_b128 v155, v[92:95] offset:15360
  v_pk_mul_f32 v[100:101], v[32:33], s[56:57]
  v_exp_f32 v100, v100 clamp
  v_exp_f32 v101, v101 clamp
  v_max_f32 v32, 0, v32
  v_max_f32 v33, 0, v33
  v_pk_add_f32 v[100:101], v[100:101], s[58:59]
  v_pk_add_f32 v[32:33], v[32:33], v[100:101]
  v_cvt_pk_bf16_f32 v80, v32, v33
  v_pk_mul_f32 v[100:101], v[34:35], s[56:57]
  v_exp_f32 v100, v100 clamp
  v_exp_f32 v101, v101 clamp
  v_max_f32 v34, 0, v34
  v_max_f32 v35, 0, v35
  v_pk_add_f32 v[100:101], v[100:101], s[58:59]
  v_pk_add_f32 v[34:35], v[34:35], v[100:101]
  v_cvt_pk_bf16_f32 v81, v34, v35
  v_pk_mul_f32 v[100:101], v[36:37], s[56:57]
  v_exp_f32 v100, v100 clamp
  v_exp_f32 v101, v101 clamp
  v_max_f32 v36, 0, v36
  v_max_f32 v37, 0, v37
  v_pk_add_f32 v[100:101], v[100:101], s[58:59]
  v_pk_add_f32 v[36:37], v[36:37], v[100:101]
  v_cvt_pk_bf16_f32 v82, v36, v37
  v_pk_mul_f32 v[100:101], v[38:39], s[56:57]
  v_exp_f32 v100, v100 clamp
  v_exp_f32 v101, v101 clamp
  v_max_f32 v38, 0, v38
  v_max_f32 v39, 0, v39
  v_pk_add_f32 v[100:101], v[100:101], s[58:59]
  v_pk_add_f32 v[38:39], v[38:39], v[100:101]
  v_cvt_pk_bf16_f32 v83, v38, v39
  ds_write_b128 v155, v[80:83] offset:2048
  v_pk_mul_f32 v[102:103], v[40:41], s[56:57]
  v_exp_f32 v102, v102 clamp
  v_exp_f32 v103, v103 clamp
  v_max_f32 v40, 0, v40
  v_max_f32 v41, 0, v41
  v_pk_add_f32 v[102:103], v[102:103], s[58:59]
  v_pk_add_f32 v[40:41], v[40:41], v[102:103]
  v_cvt_pk_bf16_f32 v84, v40, v41
  v_pk_mul_f32 v[102:103], v[42:43], s[56:57]
  v_exp_f32 v102, v102 clamp
  v_exp_f32 v103, v103 clamp
  v_max_f32 v42, 0, v42
  v_max_f32 v43, 0, v43
  v_pk_add_f32 v[102:103], v[102:103], s[58:59]
  v_pk_add_f32 v[42:43], v[42:43], v[102:103]
  v_cvt_pk_bf16_f32 v85, v42, v43
  v_pk_mul_f32 v[102:103], v[44:45], s[56:57]
  v_exp_f32 v102, v102 clamp
  v_exp_f32 v103, v103 clamp
  v_max_f32 v44, 0, v44
  v_max_f32 v45, 0, v45
  v_pk_add_f32 v[102:103], v[102:103], s[58:59]
  v_pk_add_f32 v[44:45], v[44:45], v[102:103]
  v_cvt_pk_bf16_f32 v86, v44, v45
  v_pk_mul_f32 v[102:103], v[46:47], s[56:57]
  v_exp_f32 v102, v102 clamp
  v_exp_f32 v103, v103 clamp
  v_max_f32 v46, 0, v46
  v_max_f32 v47, 0, v47
  v_pk_add_f32 v[102:103], v[102:103], s[58:59]
  v_pk_add_f32 v[46:47], v[46:47], v[102:103]
  v_cvt_pk_bf16_f32 v87, v46, v47
  ds_write_b128 v155, v[84:87] offset:12288
  v_pk_mul_f32 v[104:105], v[16:17], s[56:57]
  v_exp_f32 v104, v104 clamp
  v_exp_f32 v105, v105 clamp
  v_max_f32 v16, 0, v16
  v_max_f32 v17, 0, v17
  v_pk_add_f32 v[104:105], v[104:105], s[58:59]
  v_pk_add_f32 v[16:17], v[16:17], v[104:105]
  v_cvt_pk_bf16_f32 v88, v16, v17
  v_pk_mul_f32 v[104:105], v[18:19], s[56:57]
  v_exp_f32 v104, v104 clamp
  v_exp_f32 v105, v105 clamp
  v_max_f32 v18, 0, v18
  v_max_f32 v19, 0, v19
  v_pk_add_f32 v[104:105], v[104:105], s[58:59]
  v_pk_add_f32 v[18:19], v[18:19], v[104:105]
  v_cvt_pk_bf16_f32 v89, v18, v19
  v_pk_mul_f32 v[104:105], v[20:21], s[56:57]
  v_exp_f32 v104, v104 clamp
  v_exp_f32 v105, v105 clamp
  v_max_f32 v20, 0, v20
  v_max_f32 v21, 0, v21
  v_pk_add_f32 v[104:105], v[104:105], s[58:59]
  v_pk_add_f32 v[20:21], v[20:21], v[104:105]
  v_cvt_pk_bf16_f32 v90, v20, v21
  v_pk_mul_f32 v[104:105], v[22:23], s[56:57]
  v_exp_f32 v104, v104 clamp
  v_exp_f32 v105, v105 clamp
  v_max_f32 v22, 0, v22
  v_max_f32 v23, 0, v23
  v_pk_add_f32 v[104:105], v[104:105], s[58:59]
  v_pk_add_f32 v[22:23], v[22:23], v[104:105]
  v_cvt_pk_bf16_f32 v91, v22, v23
  ds_write_b128 v155, v[88:91] offset:1024
  v_pk_mul_f32 v[106:107], v[24:25], s[56:57]
  v_exp_f32 v106, v106 clamp
  v_exp_f32 v107, v107 clamp
  v_max_f32 v24, 0, v24
  v_max_f32 v25, 0, v25
  v_pk_add_f32 v[106:107], v[106:107], s[58:59]
  v_pk_add_f32 v[24:25], v[24:25], v[106:107]
  v_cvt_pk_bf16_f32 v92, v24, v25
  v_pk_mul_f32 v[106:107], v[26:27], s[56:57]
  v_exp_f32 v106, v106 clamp
  v_exp_f32 v107, v107 clamp
  v_max_f32 v26, 0, v26
  v_max_f32 v27, 0, v27
  v_pk_add_f32 v[106:107], v[106:107], s[58:59]
  v_pk_add_f32 v[26:27], v[26:27], v[106:107]
  v_cvt_pk_bf16_f32 v93, v26, v27
  v_pk_mul_f32 v[106:107], v[28:29], s[56:57]
  v_exp_f32 v106, v106 clamp
  v_exp_f32 v107, v107 clamp
  v_max_f32 v28, 0, v28
  v_max_f32 v29, 0, v29
  v_pk_add_f32 v[106:107], v[106:107], s[58:59]
  v_pk_add_f32 v[28:29], v[28:29], v[106:107]
  v_cvt_pk_bf16_f32 v94, v28, v29
  v_pk_mul_f32 v[106:107], v[30:31], s[56:57]
  v_exp_f32 v106, v106 clamp
  v_exp_f32 v107, v107 clamp
  v_max_f32 v30, 0, v30
  v_max_f32 v31, 0, v31
  v_pk_add_f32 v[106:107], v[106:107], s[58:59]
  v_pk_add_f32 v[30:31], v[30:31], v[106:107]
  v_cvt_pk_bf16_f32 v95, v30, v31
  ds_write_b128 v155, v[92:95] offset:11264
  v_pk_mul_f32 v[100:101], v[0:1], s[56:57]
  v_exp_f32 v100, v100 clamp
  v_exp_f32 v101, v101 clamp
  v_max_f32 v0, 0, v0
  v_max_f32 v1, 0, v1
  v_pk_add_f32 v[100:101], v[100:101], s[58:59]
  v_pk_add_f32 v[0:1], v[0:1], v[100:101]
  v_cvt_pk_bf16_f32 v80, v0, v1
  v_pk_mul_f32 v[100:101], v[2:3], s[56:57]
  v_exp_f32 v100, v100 clamp
  v_exp_f32 v101, v101 clamp
  v_max_f32 v2, 0, v2
  v_max_f32 v3, 0, v3
  v_pk_add_f32 v[100:101], v[100:101], s[58:59]
  v_pk_add_f32 v[2:3], v[2:3], v[100:101]
  v_cvt_pk_bf16_f32 v81, v2, v3
  v_pk_mul_f32 v[100:101], v[4:5], s[56:57]
  v_exp_f32 v100, v100 clamp
  v_exp_f32 v101, v101 clamp
  v_max_f32 v4, 0, v4
  v_max_f32 v5, 0, v5
  v_pk_add_f32 v[100:101], v[100:101], s[58:59]
  v_pk_add_f32 v[4:5], v[4:5], v[100:101]
  v_cvt_pk_bf16_f32 v82, v4, v5
  v_pk_mul_f32 v[100:101], v[6:7], s[56:57]
  v_exp_f32 v100, v100 clamp
  v_exp_f32 v101, v101 clamp
  v_max_f32 v6, 0, v6
  v_max_f32 v7, 0, v7
  v_pk_add_f32 v[100:101], v[100:101], s[58:59]
  v_pk_add_f32 v[6:7], v[6:7], v[100:101]
  v_cvt_pk_bf16_f32 v83, v6, v7
  ds_write_b128 v155, v[80:83] offset:0
  v_pk_mul_f32 v[102:103], v[8:9], s[56:57]
  v_exp_f32 v102, v102 clamp
  v_exp_f32 v103, v103 clamp
  v_max_f32 v8, 0, v8
  v_max_f32 v9, 0, v9
  v_pk_add_f32 v[102:103], v[102:103], s[58:59]
  v_pk_add_f32 v[8:9], v[8:9], v[102:103]
  v_cvt_pk_bf16_f32 v84, v8, v9
  v_pk_mul_f32 v[102:103], v[10:11], s[56:57]
  v_exp_f32 v102, v102 clamp
  v_exp_f32 v103, v103 clamp
  v_max_f32 v10, 0, v10
  v_max_f32 v11, 0, v11
  v_pk_add_f32 v[102:103], v[102:103], s[58:59]
  v_pk_add_f32 v[10:11], v[10:11], v[102:103]
  v_cvt_pk_bf16_f32 v85, v10, v11
  v_pk_mul_f32 v[102:103], v[12:13], s[56:57]
  v_exp_f32 v102, v102 clamp
  v_exp_f32 v103, v103 clamp
  v_max_f32 v12, 0, v12
  v_max_f32 v13, 0, v13
  v_pk_add_f32 v[102:103], v[102:103], s[58:59]
  v_pk_add_f32 v[12:13], v[12:13], v[102:103]
  v_cvt_pk_bf16_f32 v86, v12, v13
  v_pk_mul_f32 v[102:103], v[14:15], s[56:57]
  v_exp_f32 v102, v102 clamp
  v_exp_f32 v103, v103 clamp
  v_max_f32 v14, 0, v14
  v_max_f32 v15, 0, v15
  v_pk_add_f32 v[102:103], v[102:103], s[58:59]
  v_pk_add_f32 v[14:15], v[14:15], v[102:103]
  v_cvt_pk_bf16_f32 v87, v14, v15
  ds_write_b128 v155, v[84:87] offset:10240
  s_branch L_g_wcj_11
L_g_wc1_10:
  v_cvt_pk_bf16_f32 v80, v64, v65
  v_cvt_pk_bf16_f32 v81, v66, v67
  v_cvt_pk_bf16_f32 v82, v68, v69
  v_cvt_pk_bf16_f32 v83, v70, v71
  ds_write_b128 v155, v[80:83] offset:9216
  v_cvt_pk_bf16_f32 v84, v72, v73
  v_cvt_pk_bf16_f32 v85, v74, v75
  v_cvt_pk_bf16_f32 v86, v76, v77
  v_cvt_pk_bf16_f32 v87, v78, v79
  ds_write_b128 v155, v[84:87] offset:19456
  v_cvt_pk_bf16_f32 v88, v48, v49
  v_cvt_pk_bf16_f32 v89, v50, v51
  v_cvt_pk_bf16_f32 v90, v52, v53
  v_cvt_pk_bf16_f32 v91, v54, v55
  ds_write_b128 v155, v[88:91] offset:8192
  v_cvt_pk_bf16_f32 v92, v56, v57
  v_cvt_pk_bf16_f32 v93, v58, v59
  v_cvt_pk_bf16_f32 v94, v60, v61
  v_cvt_pk_bf16_f32 v95, v62, v63
  ds_write_b128 v155, v[92:95] offset:18432
  v_cvt_pk_bf16_f32 v80, v32, v33
  v_cvt_pk_bf16_f32 v81, v34, v35
  v_cvt_pk_bf16_f32 v82, v36, v37
  v_cvt_pk_bf16_f32 v83, v38, v39
  ds_write_b128 v155, v[80:83] offset:7168
  v_cvt_pk_bf16_f32 v84, v40, v41
  v_cvt_pk_bf16_f32 v85, v42, v43
  v_cvt_pk_bf16_f32 v86, v44, v45
  v_cvt_pk_bf16_f32 v87, v46, v47
  ds_write_b128 v155, v[84:87] offset:17408
  v_pk_mul_f32 v[104:105], v[16:17], s[56:57]
  v_exp_f32 v104, v104 clamp
  v_exp_f32 v105, v105 clamp
  v_max_f32 v16, 0, v16
  v_max_f32 v17, 0, v17
  v_pk_add_f32 v[104:105], v[104:105], s[58:59]
  v_pk_add_f32 v[16:17], v[16:17], v[104:105]
  v_cvt_pk_bf16_f32 v88, v16, v17
  v_pk_mul_f32 v[104:105], v[18:19], s[56:57]
  v_exp_f32 v104, v104 clamp
  v_exp_f32 v105, v105 clamp
  v_max_f32 v18, 0, v18
  v_max_f32 v19, 0, v19
  v_pk_add_f32 v[104:105], v[104:105], s[58:59]
  v_pk_add_f32 v[18:19], v[18:19], v[104:105]
  v_cvt_pk_bf16_f32 v89, v18, v19
  v_pk_mul_f32 v[104:105], v[20:21], s[56:57]
  v_exp_f32 v104, v104 clamp
  v_exp_f32 v105, v105 clamp
  v_max_f32 v20, 0, v20
  v_max_f32 v21, 0, v21
  v_pk_add_f32 v[104:105], v[104:105], s[58:59]
  v_pk_add_f32 v[20:21], v[20:21], v[104:105]
  v_cvt_pk_bf16_f32 v90, v20, v21
  v_pk_mul_f32 v[104:105], v[22:23], s[56:57]
  v_exp_f32 v104, v104 clamp
  v_exp_f32 v105, v105 clamp
  v_max_f32 v22, 0, v22
  v_max_f32 v23, 0, v23
  v_pk_add_f32 v[104:105], v[104:105], s[58:59]
  v_pk_add_f32 v[22:23], v[22:23], v[104:105]
  v_cvt_pk_bf16_f32 v91, v22, v23
  ds_write_b128 v155, v[88:91] offset:4096
  v_pk_mul_f32 v[106:107], v[24:25], s[56:57]
  v_exp_f32 v106, v106 clamp
  v_exp_f32 v107, v107 clamp
  v_max_f32 v24, 0, v24
  v_max_f32 v25, 0, v25
  v_pk_add_f32 v[106:107], v[106:107], s[58:59]
  v_pk_add_f32 v[24:25], v[24:25], v[106:107]
  v_cvt_pk_bf16_f32 v92, v24, v25
  v_pk_mul_f32 v[106:107], v[26:27], s[56:57]
  v_exp_f32 v106, v106 clamp
  v_exp_f32 v107, v107 clamp
  v_max_f32 v26, 0, v26
  v_max_f32 v27, 0, v27
  v_pk_add_f32 v[106:107], v[106:107], s[58:59]
  v_pk_add_f32 v[26:27], v[26:27], v[106:107]
  v_cvt_pk_bf16_f32 v93, v26, v27
  v_pk_mul_f32 v[106:107], v[28:29], s[56:57]
  v_exp_f32 v106, v106 clamp
  v_exp_f32 v107, v107 clamp
  v_max_f32 v28, 0, v28
  v_max_f32 v29, 0, v29
  v_pk_add_f32 v[106:107], v[106:107], s[58:59]
  v_pk_add_f32 v[28:29], v[28:29], v[106:107]
  v_cvt_pk_bf16_f32 v94, v28, v29
  v_pk_mul_f32 v[106:107], v[30:31], s[56:57]
  v_exp_f32 v106, v106 clamp
  v_exp_f32 v107, v107 clamp
  v_max_f32 v30, 0, v30
  v_max_f32 v31, 0, v31
  v_pk_add_f32 v[106:107], v[106:107], s[58:59]
  v_pk_add_f32 v[30:31], v[30:31], v[106:107]
  v_cvt_pk_bf16_f32 v95, v30, v31
  ds_write_b128 v155, v[92:95] offset:14336
  v_pk_mul_f32 v[100:101], v[0:1], s[56:57]
  v_exp_f32 v100, v100 clamp
  v_exp_f32 v101, v101 clamp
  v_max_f32 v0, 0, v0
  v_max_f32 v1, 0, v1
  v_pk_add_f32 v[100:101], v[100:101], s[58:59]
  v_pk_add_f32 v[0:1], v[0:1], v[100:101]
  v_cvt_pk_bf16_f32 v80, v0, v1
  v_pk_mul_f32 v[100:101], v[2:3], s[56:57]
  v_exp_f32 v100, v100 clamp
  v_exp_f32 v101, v101 clamp
  v_max_f32 v2, 0, v2
  v_max_f32 v3, 0, v3
  v_pk_add_f32 v[100:101], v[100:101], s[58:59]
  v_pk_add_f32 v[2:3], v[2:3], v[100:101]
  v_cvt_pk_bf16_f32 v81, v2, v3
  v_pk_mul_f32 v[100:101], v[4:5], s[56:57]
  v_exp_f32 v100, v100 clamp
  v_exp_f32 v101, v101 clamp
  v_max_f32 v4, 0, v4
  v_max_f32 v5, 0, v5
  v_pk_add_f32 v[100:101], v[100:101], s[58:59]
  v_pk_add_f32 v[4:5], v[4:5], v[100:101]
  v_cvt_pk_bf16_f32 v82, v4, v5
  v_pk_mul_f32 v[100:101], v[6:7], s[56:57]
  v_exp_f32 v100, v100 clamp
  v_exp_f32 v101, v101 clamp
  v_max_f32 v6, 0, v6
  v_max_f32 v7, 0, v7
  v_pk_add_f32 v[100:101], v[100:101], s[58:59]
  v_pk_add_f32 v[6:7], v[6:7], v[100:101]
  v_cvt_pk_bf16_f32 v83, v6, v7
  ds_write_b128 v155, v[80:83] offset:3072
  v_pk_mul_f32 v[102:103], v[8:9], s[56:57]
  v_exp_f32 v102, v102 clamp
  v_exp_f32 v103, v103 clamp
  v_max_f32 v8, 0, v8
  v_max_f32 v9, 0, v9
  v_pk_add_f32 v[102:103], v[102:103], s[58:59]
  v_pk_add_f32 v[8:9], v[8:9], v[102:103]
  v_cvt_pk_bf16_f32 v84, v8, v9
  v_pk_mul_f32 v[102:103], v[10:11], s[56:57]
  v_exp_f32 v102, v102 clamp
  v_exp_f32 v103, v103 clamp
  v_max_f32 v10, 0, v10
  v_max_f32 v11, 0, v11
  v_pk_add_f32 v[102:103], v[102:103], s[58:59]
  v_pk_add_f32 v[10:11], v[10:11], v[102:103]
  v_cvt_pk_bf16_f32 v85, v10, v11
  v_pk_mul_f32 v[102:103], v[12:13], s[56:57]
  v_exp_f32 v102, v102 clamp
  v_exp_f32 v103, v103 clamp
  v_max_f32 v12, 0, v12
  v_max_f32 v13, 0, v13
  v_pk_add_f32 v[102:103], v[102:103], s[58:59]
  v_pk_add_f32 v[12:13], v[12:13], v[102:103]
  v_cvt_pk_bf16_f32 v86, v12, v13
  v_pk_mul_f32 v[102:103], v[14:15], s[56:57]
  v_exp_f32 v102, v102 clamp
  v_exp_f32 v103, v103 clamp
  v_max_f32 v14, 0, v14
  v_max_f32 v15, 0, v15
  v_pk_add_f32 v[102:103], v[102:103], s[58:59]
  v_pk_add_f32 v[14:15], v[14:15], v[102:103]
  v_cvt_pk_bf16_f32 v87, v14, v15
  ds_write_b128 v155, v[84:87] offset:13312
L_g_wcj_11:
  s_waitcnt vmcnt(1)
L_u_pn_12:
  v_readfirstlane_b32 s52, v172
  s_nop 0
  s_cmp_lg_u32 s52, 0
  s_cbranch_scc1 L_u_go_13
  s_sleep 2
  s_add_u32 s93, s93, 1
  s_cmp_gt_u32 s93, 300000
  s_cbranch_scc1 L_u_go_13
  global_load_dword v172, v171, s[48:49] sc1
  s_waitcnt vmcnt(0)
  s_branch L_u_pn_12
L_u_go_13:
L_u_pl_14:
  v_cmp_ne_u32 vcc, s52, v170
  s_cbranch_vccz L_u_ok_15
  s_sleep 4
  s_add_u32 s93, s93, 1
  s_cmp_gt_u32 s93, 300000
  s_cbranch_scc1 L_u_ok_15
  global_load_dword v170, v169, s[50:51] sc1
  s_waitcnt vmcnt(0)
  s_branch L_u_pl_14
L_u_ok_15:
  global_load_dwordx4 v[160:163], v173, s[50:51] sc1
  global_load_dwordx4 v[164:167], v173, s[50:51] offset:16 sc1
  global_load_dword v168, v173, s[50:51] offset:-4 sc1
  s_lshl_b32 s34, s28, 10
  v_lshl_add_u32 v155, v152, 4, s34
  s_waitcnt lgkmcnt(0)
  s_barrier
  ds_read_b128 v[80:83], v155 offset:0
  ds_read_b128 v[84:87], v155 offset:1024
  ds_read_b128 v[88:91], v155 offset:5120
  ds_read_b128 v[92:95], v155 offset:6144
  ds_read_b128 v[96:99], v155 offset:10240
  ds_read_b128 v[100:103], v155 offset:11264
  ds_read_b128 v[104:107], v155 offset:15360
  ds_read_b128 v[108:111], v155 offset:16384
  v_mov_b32 v64, 0x3f803f80
  v_mov_b32 v65, 0x3f803f80
  v_mov_b32 v66, 0x3f803f80
  v_mov_b32 v67, 0x3f803f80
  s_waitcnt lgkmcnt(4)
  v_mfma_f32_16x16x32_bf16 v[0:3], v[88:91], v[80:83], 0
  v_mfma_f32_16x16x32_bf16 v[4:7], v[88:91], v[84:87], 0
  v_mfma_f32_16x16x32_bf16 v[8:11], v[92:95], v[80:83], 0
  v_mfma_f32_16x16x32_bf16 v[12:15], v[92:95], v[84:87], 0
  v_mfma_f32_16x16x32_bf16 v[16:19], v[64:67], v[80:83], 0
  v_mfma_f32_16x16x32_bf16 v[20:23], v[64:67], v[84:87], 0
  ds_read_b128 v[80:83], v155 offset:20480
  ds_read_b128 v[84:87], v155 offset:21504
  ds_read_b128 v[88:91], v155 offset:25600
  ds_read_b128 v[92:95], v155 offset:26624
  s_waitcnt lgkmcnt(4)
  v_mfma_f32_16x16x32_bf16 v[0:3], v[104:107], v[96:99], v[0:3]
  v_mfma_f32_16x16x32_bf16 v[4:7], v[104:107], v[100:103], v[4:7]
  v_mfma_f32_16x16x32_bf16 v[8:11], v[108:111], v[96:99], v[8:11]
  v_mfma_f32_16x16x32_bf16 v[12:15], v[108:111], v[100:103], v[12:15]
  v_mfma_f32_16x16x32_bf16 v[16:19], v[64:67], v[96:99], v[16:19]
  v_mfma_f32_16x16x32_bf16 v[20:23], v[64:67], v[100:103], v[20:23]
  ds_read_b128 v[96:99], v155 offset:30720
  ds_read_b128 v[100:103], v155 offset:31744
  ds_read_b128 v[104:107], v155 offset:35840
  ds_read_b128 v[108:111], v155 offset:36864
  s_waitcnt lgkmcnt(4)
  v_mfma_f32_16x16x32_bf16 v[0:3], v[88:91], v[80:83], v[0:3]
  v_mfma_f32_16x16x32_bf16 v[4:7], v[88:91], v[84:87], v[4:7]
  v_mfma_f32_16x16x32_bf16 v[8:11], v[92:95], v[80:83], v[8:11]
  v_mfma_f32_16x16x32_bf16 v[12:15], v[92:95], v[84:87], v[12:15]
  v_mfma_f32_16x16x32_bf16 v[16:19], v[64:67], v[80:83], v[16:19]
  v_mfma_f32_16x16x32_bf16 v[20:23], v[64:67], v[84:87], v[20:23]
  s_waitcnt lgkmcnt(0)
  v_mfma_f32_16x16x32_bf16 v[0:3], v[104:107], v[96:99], v[0:3]
  v_mfma_f32_16x16x32_bf16 v[4:7], v[104:107], v[100:103], v[4:7]
  v_mfma_f32_16x16x32_bf16 v[8:11], v[108:111], v[96:99], v[8:11]
  v_mfma_f32_16x16x32_bf16 v[12:15], v[108:111], v[100:103], v[12:15]
  v_mfma_f32_16x16x32_bf16 v[16:19], v[64:67], v[96:99], v[16:19]
  v_mfma_f32_16x16x32_bf16 v[20:23], v[64:67], v[100:103], v[20:23]
  s_lshl_b32 s34, s28, 4
  v_add_u32 v60, s34, v153
  v_mul_u32_u24 v40, 3277, v60
  v_lshrrev_b32 v40, 16, v40
  v_mul_u32_u24 v61, 20, v40
  v_sub_u32 v60, v60, v61
  v_lshlrev_b32 v42, 2, v60
  v_lshl_add_u32 v60, v154, 2, s34
  v_add_u32 v60, 0, v60
  v_mul_u32_u24 v44, 3277, v60
  v_lshrrev_b32 v44, 16, v44
  v_add_u32 v60, v60, v44
  v_mul_u32_u24 v52, 80, v60
  v_lshl_add_u32 v60, v154, 2, s34
  v_add_u32 v60, 1, v60
  v_mul_u32_u24 v45, 3277, v60
  v_lshrrev_b32 v45, 16, v45
  v_add_u32 v60, v60, v45
  v_mul_u32_u24 v53, 80, v60
  v_lshl_add_u32 v60, v154, 2, s34
  v_add_u32 v60, 2, v60
  v_mul_u32_u24 v46, 3277, v60
  v_lshrrev_b32 v46, 16, v46
  v_add_u32 v60, v60, v46
  v_mul_u32_u24 v54, 80, v60
  v_lshl_add_u32 v60, v154, 2, s34
  v_add_u32 v60, 3, v60
  v_mul_u32_u24 v47, 3277, v60
  v_lshrrev_b32 v47, 16, v47
  v_add_u32 v60, v60, v47
  v_mul_u32_u24 v55, 80, v60
  v_add_u32 v60, s34, v153
  v_add_u32 v60, 16, v60
  v_mul_u32_u24 v41, 3277, v60
  v_lshrrev_b32 v41, 16, v41
  v_mul_u32_u24 v61, 20, v41
  v_sub_u32 v60, v60, v61
  v_lshlrev_b32 v43, 2, v60
  v_lshl_add_u32 v60, v154, 2, s34
  v_add_u32 v60, 16, v60
  v_mul_u32_u24 v48, 3277, v60
  v_lshrrev_b32 v48, 16, v48
  v_add_u32 v60, v60, v48
  v_mul_u32_u24 v56, 80, v60
  v_lshl_add_u32 v60, v154, 2, s34
  v_add_u32 v60, 17, v60
  v_mul_u32_u24 v49, 3277, v60
  v_lshrrev_b32 v49, 16, v49
  v_add_u32 v60, v60, v49
  v_mul_u32_u24 v57, 80, v60
  v_lshl_add_u32 v60, v154, 2, s34
  v_add_u32 v60, 18, v60
  v_mul_u32_u24 v50, 3277, v60
  v_lshrrev_b32 v50, 16, v50
  v_add_u32 v60, v60, v50
  v_mul_u32_u24 v58, 80, v60
  v_lshl_add_u32 v60, v154, 2, s34
  v_add_u32 v60, 19, v60
  v_mul_u32_u24 v51, 3277, v60
  v_lshrrev_b32 v51, 16, v51
  v_add_u32 v60, v60, v51
  v_mul_u32_u24 v59, 80, v60
  v_mov_b32 v62, 6720
  v_mov_b32 v63, 1600
  v_cmp_eq_u32 vcc, v44, v41
  v_add_u32 v68, v52, v43
  s_nop 0
  v_cndmask_b32 v68, v62, v68, vcc
  ds_write_b32 v68, v4 offset:40960
  v_cmp_eq_u32 vcc, v45, v41
  v_add_u32 v69, v53, v43
  s_nop 0
  v_cndmask_b32 v69, v62, v69, vcc
  ds_write_b32 v69, v5 offset:40960
  v_cmp_eq_u32 vcc, v46, v41
  v_add_u32 v70, v54, v43
  s_nop 0
  v_cndmask_b32 v70, v62, v70, vcc
  ds_write_b32 v70, v6 offset:40960
  v_cmp_eq_u32 vcc, v47, v41
  v_add_u32 v71, v55, v43
  s_nop 0
  v_cndmask_b32 v71, v62, v71, vcc
  ds_write_b32 v71, v7 offset:40960
  v_cmp_eq_u32 vcc, v48, v40
  v_add_u32 v68, v56, v42
  s_nop 0
  v_cndmask_b32 v68, v62, v68, vcc
  ds_write_b32 v68, v8 offset:40960
  v_cmp_eq_u32 vcc, v49, v40
  v_add_u32 v69, v57, v42
  s_nop 0
  v_cndmask_b32 v69, v62, v69, vcc
  ds_write_b32 v69, v9 offset:40960
  v_cmp_eq_u32 vcc, v50, v40
  v_add_u32 v70, v58, v42
  s_nop 0
  v_cndmask_b32 v70, v62, v70, vcc
  ds_write_b32 v70, v10 offset:40960
  v_cmp_eq_u32 vcc, v51, v40
  v_add_u32 v71, v59, v42
  s_nop 0
  v_cndmask_b32 v71, v62, v71, vcc
  ds_write_b32 v71, v11 offset:40960
  v_cmp_eq_u32 vcc, v48, v41
  v_add_u32 v68, v56, v43
  s_nop 0
  v_cndmask_b32 v68, v62, v68, vcc
  ds_write_b32 v68, v12 offset:40960
  v_cmp_eq_u32 vcc, v49, v41
  v_add_u32 v69, v57, v43
  s_nop 0
  v_cndmask_b32 v69, v62, v69, vcc
  ds_write_b32 v69, v13 offset:40960
  v_cmp_eq_u32 vcc, v50, v41
  v_add_u32 v70, v58, v43
  s_nop 0
  v_cndmask_b32 v70, v62, v70, vcc
  ds_write_b32 v70, v14 offset:40960
  v_cmp_eq_u32 vcc, v51, v41
  v_add_u32 v71, v59, v43
  s_nop 0
  v_cndmask_b32 v71, v62, v71, vcc
  ds_write_b32 v71, v15 offset:40960
  v_mul_u32_u24 v73, 1680, v41
  v_add3_u32 v73, v73, v43, v63
  ds_write_b32 v73, v20 offset:40960
  s_cmp_lg_u32 s28, 0
  s_cbranch_scc1 L_g_sk_16
  v_cmp_eq_u32 vcc, v44, v40
  v_add_u32 v68, v52, v42
  s_nop 0
  v_cndmask_b32 v68, v62, v68, vcc
  ds_write_b32 v68, v0 offset:40960
  v_cmp_eq_u32 vcc, v45, v40
  v_add_u32 v69, v53, v42
  s_nop 0
  v_cndmask_b32 v69, v62, v69, vcc
  ds_write_b32 v69, v1 offset:40960
  v_cmp_eq_u32 vcc, v46, v40
  v_add_u32 v70, v54, v42
  s_nop 0
  v_cndmask_b32 v70, v62, v70, vcc
  ds_write_b32 v70, v2 offset:40960
  v_cmp_eq_u32 vcc, v47, v40
  v_add_u32 v71, v55, v42
  s_nop 0
  v_cndmask_b32 v71, v62, v71, vcc
  ds_write_b32 v71, v3 offset:40960
  v_mul_u32_u24 v72, 1680, v40
  v_add3_u32 v72, v72, v42, v63
  ds_write_b32 v72, v16 offset:40960
L_g_sk_16:
  s_mul_i32 s34, s4, 6720
  s_add_u32 s34, s34, 7995392
  s_add_u32 s44, s50, s34
  s_addc_u32 s45, s51, 0
  s_mov_b32 s46, 6720
  s_mov_b32 s47, 0x20000
  s_lshl_b32 s34, s28, 8
  v_lshl_add_u32 v155, v152, 2, s34
  s_waitcnt lgkmcnt(0)
  s_barrier
  ds_read_b32 v80, v155 offset:40960
  ds_read_b32 v81, v155 offset:41984
  ds_read_b32 v82, v155 offset:43008
  ds_read_b32 v83, v155 offset:44032
  ds_read_b32 v84, v155 offset:45056
  ds_read_b32 v85, v155 offset:46080
  ds_read_b32 v86, v155 offset:47104
L_g_z_17:
  s_waitcnt vmcnt(0)
  v_readfirstlane_b32 s34, v131
  s_nop 0
  s_cmp_lg_u32 s34, 0
  s_cbranch_scc1 L_g_zo_18
  s_sleep 2
  s_add_u32 s93, s93, 1
  s_cmp_gt_u32 s93, 300000
  s_cbranch_scc1 L_g_zo_18
  global_load_dword v131, v130, s[48:49] sc1
  s_branch L_g_z_17
L_g_zo_18:
  s_waitcnt lgkmcnt(0)
  buffer_atomic_add_f32 v80, v155, s[44:47], 0 offen offset:0
  buffer_atomic_add_f32 v81, v155, s[44:47], 0 offen offset:1024
  buffer_atomic_add_f32 v82, v155, s[44:47], 0 offen offset:2048
  buffer_atomic_add_f32 v83, v155, s[44:47], 0 offen offset:3072
  s_mov_b32 s34, 4096
  buffer_atomic_add_f32 v84, v155, s[44:47], s34 offen offset:0
  buffer_atomic_add_f32 v85, v155, s[44:47], s34 offen offset:1024
  buffer_atomic_add_f32 v86, v155, s[44:47], s34 offen offset:2048
  s_branch L_g_fin_8
L_g_q_7:
L_g_loop_19:
  s_waitcnt vmcnt(5)
  s_barrier
  s_waitcnt lgkmcnt(0)
  v_mfma_f32_16x16x32_bf16 v[0:3], v[96:99], v[80:83], v[0:3]
  ds_read_b128 v[116:119], v159 offset:18432
  v_mfma_f32_16x16x32_bf16 v[4:7], v[96:99], v[84:87], v[4:7]
  ds_read_b128 v[120:123], v159 offset:19456
  v_mfma_f32_16x16x32_bf16 v[8:11], v[96:99], v[88:91], v[8:11]
  ds_read_b64_tr_b16 v[132:133], v157 offset:26624
  ds_read_b64_tr_b16 v[134:135], v157 offset:27904
  v_mfma_f32_16x16x32_bf16 v[12:15], v[96:99], v[92:95], v[12:15]
  s_add_u32 m0, s35, 55296
  s_nop 0
  buffer_load_dwordx4 v152, s[8:11], s37 offen lds
  v_mfma_f32_16x16x32_bf16 v[16:19], v[100:103], v[80:83], v[16:19]
  ds_read_b128 v[124:127], v159 offset:20480
  v_mfma_f32_16x16x32_bf16 v[20:23], v[100:103], v[84:87], v[20:23]
  ds_read_b128 v[128:131], v159 offset:21504
  v_mfma_f32_16x16x32_bf16 v[24:27], v[100:103], v[88:91], v[24:27]
  ds_read_b64_tr_b16 v[136:137], v158 offset:26656
  ds_read_b64_tr_b16 v[138:139], v158 offset:27936
  v_mfma_f32_16x16x32_bf16 v[28:31], v[100:103], v[92:95], v[28:31]
  s_add_u32 m0, s36, 55296
  s_nop 0
  buffer_load_dwordx4 v154, s[12:15], s38 offen lds
  v_mfma_f32_16x16x32_bf16 v[32:35], v[104:107], v[80:83], v[32:35]
  ds_read_b64_tr_b16 v[140:141], v157 offset:26688
  ds_read_b64_tr_b16 v[142:143], v157 offset:27968
  v_mfma_f32_16x16x32_bf16 v[36:39], v[104:107], v[84:87], v[36:39]
  s_add_u32 m0, s35, 56320
  s_nop 0
  buffer_load_dwordx4 v153, s[8:11], s37 offen lds
  s_add_u32 s37, s37, 64
  v_mfma_f32_16x16x32_bf16 v[40:43], v[104:107], v[88:91], v[40:43]
  ds_read_b64_tr_b16 v[144:145], v158 offset:26720
  ds_read_b64_tr_b16 v[146:147], v158 offset:28000
  v_mfma_f32_16x16x32_bf16 v[44:47], v[104:107], v[92:95], v[44:47]
  s_add_u32 m0, s36, 56320
  s_nop 0
  buffer_load_dwordx4 v155, s[12:15], s38 offen lds
  v_mfma_f32_16x16x32_bf16 v[48:51], v[108:111], v[80:83], v[48:51]
  ds_read_b64_tr_b16 v[148:149], v157 offset:26752
  ds_read_b64_tr_b16 v[150:151], v157 offset:28032
  v_mfma_f32_16x16x32_bf16 v[52:55], v[108:111], v[84:87], v[52:55]
  v_mfma_f32_16x16x32_bf16 v[56:59], v[108:111], v[88:91], v[56:59]
  s_add_u32 m0, s36, 57344
  s_mov_b64 exec, 0xffffffff
  buffer_load_dwordx4 v156, s[12:15], s38 offen lds
  s_mov_b64 exec, -1
  s_add_u32 s38, s38, 122880
  v_mfma_f32_16x16x32_bf16 v[60:63], v[108:111], v[92:95], v[60:63]
  v_mfma_f32_16x16x32_bf16 v[64:67], v[112:115], v[80:83], v[64:67]
  v_mfma_f32_16x16x32_bf16 v[68:71], v[112:115], v[84:87], v[68:71]
  v_mfma_f32_16x16x32_bf16 v[72:75], v[112:115], v[88:91], v[72:75]
  v_mfma_f32_16x16x32_bf16 v[76:79], v[112:115], v[92:95], v[76:79]
  s_waitcnt vmcnt(5)
  s_barrier
  s_waitcnt lgkmcnt(0)
  v_mfma_f32_16x16x32_bf16 v[0:3], v[132:135], v[116:119], v[0:3]
  ds_read_b128 v[80:83], v159 offset:36864
  v_mfma_f32_16x16x32_bf16 v[4:7], v[132:135], v[120:123], v[4:7]
  ds_read_b128 v[84:87], v159 offset:37888
  v_mfma_f32_16x16x32_bf16 v[8:11], v[132:135], v[124:127], v[8:11]
  ds_read_b64_tr_b16 v[96:97], v157 offset:45056
  ds_read_b64_tr_b16 v[98:99], v157 offset:46336
  v_mfma_f32_16x16x32_bf16 v[12:15], v[132:135], v[128:131], v[12:15]
  s_add_u32 m0, s35, 0
  s_nop 0
  buffer_load_dwordx4 v152, s[8:11], s37 offen lds
  v_mfma_f32_16x16x32_bf16 v[16:19], v[136:139], v[116:119], v[16:19]
  ds_read_b128 v[88:91], v159 offset:38912
  v_mfma_f32_16x16x32_bf16 v[20:23], v[136:139], v[120:123], v[20:23]
  ds_read_b128 v[92:95], v159 offset:39936
  v_mfma_f32_16x16x32_bf16 v[24:27], v[136:139], v[124:127], v[24:27]
  ds_read_b64_tr_b16 v[100:101], v158 offset:45088
  ds_read_b64_tr_b16 v[102:103], v158 offset:46368
  v_mfma_f32_16x16x32_bf16 v[28:31], v[136:139], v[128:131], v[28:31]
  s_add_u32 m0, s36, 0
  s_nop 0
  buffer_load_dwordx4 v154, s[12:15], s38 offen lds
  v_mfma_f32_16x16x32_bf16 v[32:35], v[140:143], v[116:119], v[32:35]
  ds_read_b64_tr_b16 v[104:105], v157 offset:45120
  ds_read_b64_tr_b16 v[106:107], v157 offset:46400
  v_mfma_f32_16x16x32_bf16 v[36:39], v[140:143], v[120:123], v[36:39]
  s_add_u32 m0, s35, 1024
  s_nop 0
  buffer_load_dwordx4 v153, s[8:11], s37 offen lds
  s_add_u32 s37, s37, 64
  v_mfma_f32_16x16x32_bf16 v[40:43], v[140:143], v[124:127], v[40:43]
  ds_read_b64_tr_b16 v[108:109], v158 offset:45152
  ds_read_b64_tr_b16 v[110:111], v158 offset:46432
  v_mfma_f32_16x16x32_bf16 v[44:47], v[140:143], v[128:131], v[44:47]
  s_add_u32 m0, s36, 1024
  s_nop 0
  buffer_load_dwordx4 v155, s[12:15], s38 offen lds
  v_mfma_f32_16x16x32_bf16 v[48:51], v[144:147], v[116:119], v[48:51]
  ds_read_b64_tr_b16 v[112:113], v157 offset:45184
  ds_read_b64_tr_b16 v[114:115], v157 offset:46464
  v_mfma_f32_16x16x32_bf16 v[52:55], v[144:147], v[120:123], v[52:55]
  v_mfma_f32_16x16x32_bf16 v[56:59], v[144:147], v[124:127], v[56:59]
  s_add_u32 m0, s36, 2048
  s_mov_b64 exec, 0xffffffff
  buffer_load_dwordx4 v156, s[12:15], s38 offen lds
  s_mov_b64 exec, -1
  s_add_u32 s38, s38, 122880
  v_mfma_f32_16x16x32_bf16 v[60:63], v[144:147], v[128:131], v[60:63]
  v_mfma_f32_16x16x32_bf16 v[64:67], v[148:151], v[116:119], v[64:67]
  v_mfma_f32_16x16x32_bf16 v[68:71], v[148:151], v[120:123], v[68:71]
  v_mfma_f32_16x16x32_bf16 v[72:75], v[148:151], v[124:127], v[72:75]
  v_mfma_f32_16x16x32_bf16 v[76:79], v[148:151], v[128:131], v[76:79]
  s_waitcnt vmcnt(5)
  s_barrier
  s_waitcnt lgkmcnt(0)
  v_mfma_f32_16x16x32_bf16 v[0:3], v[96:99], v[80:83], v[0:3]
  ds_read_b128 v[116:119], v159 offset:55296
  v_mfma_f32_16x16x32_bf16 v[4:7], v[96:99], v[84:87], v[4:7]
  ds_read_b128 v[120:123], v159 offset:56320
  v_mfma_f32_16x16x32_bf16 v[8:11], v[96:99], v[88:91], v[8:11]
  ds_read_b64_tr_b16 v[132:133], v157 offset:63488
  ds_read_b64_tr_b16 v[134:135], v157 offset:64768
  v_mfma_f32_16x16x32_bf16 v[12:15], v[96:99], v[92:95], v[12:15]
  s_add_u32 m0, s35, 18432
  s_nop 0
  buffer_load_dwordx4 v152, s[8:11], s37 offen lds
  v_mfma_f32_16x16x32_bf16 v[16:19], v[100:103], v[80:83], v[16:19]
  ds_read_b128 v[124:127], v159 offset:57344
  v_mfma_f32_16x16x32_bf16 v[20:23], v[100:103], v[84:87], v[20:23]
  ds_read_b128 v[128:131], v159 offset:58368
  v_mfma_f32_16x16x32_bf16 v[24:27], v[100:103], v[88:91], v[24:27]
  ds_read_b64_tr_b16 v[136:137], v158 offset:63520
  ds_read_b64_tr_b16 v[138:139], v158 offset:64800
  v_mfma_f32_16x16x32_bf16 v[28:31], v[100:103], v[92:95], v[28:31]
  s_add_u32 m0, s36, 18432
  s_nop 0
  buffer_load_dwordx4 v154, s[12:15], s38 offen lds
  v_mfma_f32_16x16x32_bf16 v[32:35], v[104:107], v[80:83], v[32:35]
  ds_read_b64_tr_b16 v[140:141], v157 offset:63552
  ds_read_b64_tr_b16 v[142:143], v157 offset:64832
  v_mfma_f32_16x16x32_bf16 v[36:39], v[104:107], v[84:87], v[36:39]
  s_add_u32 m0, s35, 19456
  s_nop 0
  buffer_load_dwordx4 v153, s[8:11], s37 offen lds
  s_add_u32 s37, s37, 64
  v_mfma_f32_16x16x32_bf16 v[40:43], v[104:107], v[88:91], v[40:43]
  ds_read_b64_tr_b16 v[144:145], v158 offset:63584
  ds_read_b64_tr_b16 v[146:147], v158 offset:64864
  v_mfma_f32_16x16x32_bf16 v[44:47], v[104:107], v[92:95], v[44:47]
  s_add_u32 m0, s36, 19456
  s_nop 0
  buffer_load_dwordx4 v155, s[12:15], s38 offen lds
  v_mfma_f32_16x16x32_bf16 v[48:51], v[108:111], v[80:83], v[48:51]
  ds_read_b64_tr_b16 v[148:149], v157 offset:63616
  ds_read_b64_tr_b16 v[150:151], v157 offset:64896
  v_mfma_f32_16x16x32_bf16 v[52:55], v[108:111], v[84:87], v[52:55]
  v_mfma_f32_16x16x32_bf16 v[56:59], v[108:111], v[88:91], v[56:59]
  s_add_u32 m0, s36, 20480
  s_mov_b64 exec, 0xffffffff
  buffer_load_dwordx4 v156, s[12:15], s38 offen lds
  s_mov_b64 exec, -1
  s_add_u32 s38, s38, 122880
  v_mfma_f32_16x16x32_bf16 v[60:63], v[108:111], v[92:95], v[60:63]
  v_mfma_f32_16x16x32_bf16 v[64:67], v[112:115], v[80:83], v[64:67]
  v_mfma_f32_16x16x32_bf16 v[68:71], v[112:115], v[84:87], v[68:71]
  v_mfma_f32_16x16x32_bf16 v[72:75], v[112:115], v[88:91], v[72:75]
  v_mfma_f32_16x16x32_bf16 v[76:79], v[112:115], v[92:95], v[76:79]
  s_waitcnt vmcnt(5)
  s_barrier
  s_waitcnt lgkmcnt(0)
  v_mfma_f32_16x16x32_bf16 v[0:3], v[132:135], v[116:119], v[0:3]
  ds_read_b128 v[80:83], v159 offset:0
  v_mfma_f32_16x16x32_bf16 v[4:7], v[132:135], v[120:123], v[4:7]
  ds_read_b128 v[84:87], v159 offset:1024
  v_mfma_f32_16x16x32_bf16 v[8:11], v[132:135], v[124:127], v[8:11]
  ds_read_b64_tr_b16 v[96:97], v157 offset:8192
  ds_read_b64_tr_b16 v[98:99], v157 offset:9472
  v_mfma_f32_16x16x32_bf16 v[12:15], v[132:135], v[128:131], v[12:15]
  s_add_u32 m0, s35, 36864
  s_nop 0
  buffer_load_dwordx4 v152, s[8:11], s37 offen lds
  v_mfma_f32_16x16x32_bf16 v[16:19], v[136:139], v[116:119], v[16:19]
  ds_read_b128 v[88:91], v159 offset:2048
  v_mfma_f32_16x16x32_bf16 v[20:23], v[136:139], v[120:123], v[20:23]
  ds_read_b128 v[92:95], v159 offset:3072
  v_mfma_f32_16x16x32_bf16 v[24:27], v[136:139], v[124:127], v[24:27]
  ds_read_b64_tr_b16 v[100:101], v158 offset:8224
  ds_read_b64_tr_b16 v[102:103], v158 offset:9504
  v_mfma_f32_16x16x32_bf16 v[28:31], v[136:139], v[128:131], v[28:31]
  s_add_u32 m0, s36, 36864
  s_nop 0
  buffer_load_dwordx4 v154, s[12:15], s38 offen lds
  v_mfma_f32_16x16x32_bf16 v[32:35], v[140:143], v[116:119], v[32:35]
  ds_read_b64_tr_b16 v[104:105], v157 offset:8256
  ds_read_b64_tr_b16 v[106:107], v157 offset:9536
  v_mfma_f32_16x16x32_bf16 v[36:39], v[140:143], v[120:123], v[36:39]
  s_add_u32 m0, s35, 37888
  s_nop 0
  buffer_load_dwordx4 v153, s[8:11], s37 offen lds
  s_add_u32 s37, s37, 64
  v_mfma_f32_16x16x32_bf16 v[40:43], v[140:143], v[124:127], v[40:43]
  ds_read_b64_tr_b16 v[108:109], v158 offset:8288
  ds_read_b64_tr_b16 v[110:111], v158 offset:9568
  v_mfma_f32_16x16x32_bf16 v[44:47], v[140:143], v[128:131], v[44:47]
  s_add_u32 m0, s36, 37888
  s_nop 0
  buffer_load_dwordx4 v155, s[12:15], s38 offen lds
  v_mfma_f32_16x16x32_bf16 v[48:51], v[144:147], v[116:119], v[48:51]
  ds_read_b64_tr_b16 v[112:113], v157 offset:8320
  ds_read_b64_tr_b16 v[114:115], v157 offset:9600
  v_mfma_f32_16x16x32_bf16 v[52:55], v[144:147], v[120:123], v[52:55]
  v_mfma_f32_16x16x32_bf16 v[56:59], v[144:147], v[124:127], v[56:59]
  s_add_u32 m0, s36, 38912
  s_mov_b64 exec, 0xffffffff
  buffer_load_dwordx4 v156, s[12:15], s38 offen lds
  s_mov_b64 exec, -1
  s_add_u32 s38, s38, 122880
  v_mfma_f32_16x16x32_bf16 v[60:63], v[144:147], v[128:131], v[60:63]
  v_mfma_f32_16x16x32_bf16 v[64:67], v[148:151], v[116:119], v[64:67]
  v_mfma_f32_16x16x32_bf16 v[68:71], v[148:151], v[120:123], v[68:71]
  v_mfma_f32_16x16x32_bf16 v[72:75], v[148:151], v[124:127], v[72:75]
  v_mfma_f32_16x16x32_bf16 v[76:79], v[148:151], v[128:131], v[76:79]
  s_add_u32 s41, s41, 1
  s_cmp_lt_u32 s41, 5
  s_cbranch_scc1 L_g_loop_19
  s_nop 4
  s_mov_b32 s56, 1069066811
  s_mov_b32 s57, 1069066811
  s_mov_b32 s58, 897988541
  s_mov_b32 s59, 897988541
  s_waitcnt lgkmcnt(0)
  v_mbcnt_lo_u32_b32 v152, -1, 0
  v_mbcnt_hi_u32_b32 v152, -1, v152
  v_and_b32 v153, 15, v152
  v_lshrrev_b32 v154, 4, v152
  s_waitcnt vmcnt(0)
  v_mbcnt_lo_u32_b32 v174, -1, 0
  v_mbcnt_hi_u32_b32 v174, -1, v174
  s_mul_i32 s100, s90, 820
  s_lshr_b32 s100, s100, 16
  s_lshl_b32 s100, s100, 6
  s_add_u32 s100, s100, 8126464
  v_and_b32 v169, 15, v174
  v_lshl_add_u32 v169, v169, 2, s100
  v_mov_b32 v171, 0
  global_load_dword v172, v171, s[48:49] sc1
  global_load_dword v170, v169, s[50:51] sc1
  s_lshl_b32 s100, s98, 6
  v_add_u32 v174, s100, v174
  s_lshl_b32 s100, s99, 12
  s_add_u32 s100, s100, 2621440
  v_lshl_add_u32 v173, v174, 5, s100
  s_lshr_b32 s34, s33, 4
  s_lshl_b32 s36, s53, 2
  s_add_u32 s34, s34, s36
  s_lshl_b32 s34, s34, 5
  s_sub_u32 s36, s4, 8
  s_lshl_b32 s36, s36, 3
  s_add_u32 s34, s34, s36
  s_lshl_b32 s36, s54, 2
  s_add_u32 s34, s34, s36
  s_mul_i32 s34, s34, 768
  s_add_u32 s34, s34, 8388608
  v_lshl_add_u32 v155, v153, 4, s34
  v_add_u32 v120, 0, v154
  v_mul_u32_u24 v121, 13108, v120
  v_lshrrev_b32 v121, 16, v121
  v_mul_u32_u24 v122, 5, v121
  v_sub_u32 v120, v120, v122
  v_mul_u32_u24 v121, 768, v121
  v_lshrrev_b32 v122, 1, v120
  v_lshl_add_u32 v121, v122, 8, v121
  v_and_b32 v120, 1, v120
  v_lshl_add_u32 v121, v120, 3, v121
  v_add_u32 v124, v121, v155
  v_add_u32 v120, 4, v154
  v_mul_u32_u24 v121, 13108, v120
  v_lshrrev_b32 v121, 16, v121
  v_mul_u32_u24 v122, 5, v121
  v_sub_u32 v120, v120, v122
  v_mul_u32_u24 v121, 768, v121
  v_lshrrev_b32 v122, 1, v120
  v_lshl_add_u32 v121, v122, 8, v121
  v_and_b32 v120, 1, v120
  v_lshl_add_u32 v121, v120, 3, v121
  v_add_u32 v125, v121, v155
  v_add_u32 v120, 8, v154
  v_mul_u32_u24 v121, 13108, v120
  v_lshrrev_b32 v121, 16, v121
  v_mul_u32_u24 v122, 5, v121
  v_sub_u32 v120, v120, v122
  v_mul_u32_u24 v121, 768, v121
  v_lshrrev_b32 v122, 1, v120
  v_lshl_add_u32 v121, v122, 8, v121
  v_and_b32 v120, 1, v120
  v_lshl_add_u32 v121, v120, 3, v121
  v_add_u32 v126, v121, v155
  v_add_u32 v120, 12, v154
  v_mul_u32_u24 v121, 13108, v120
  v_lshrrev_b32 v121, 16, v121
  v_mul_u32_u24 v122, 5, v121
  v_sub_u32 v120, v120, v122
  v_mul_u32_u24 v121, 768, v121
  v_lshrrev_b32 v122, 1, v120
  v_lshl_add_u32 v121, v122, 8, v121
  v_and_b32 v120, 1, v120
  v_lshl_add_u32 v121, v120, 3, v121
  v_add_u32 v127, v121, v155
  v_add_u32 v120, 16, v154
  v_mul_u32_u24 v121, 13108, v120
  v_lshrrev_b32 v121, 16, v121
  v_mul_u32_u24 v122, 5, v121
  v_sub_u32 v120, v120, v122
  v_mul_u32_u24 v121, 768, v121
  v_lshrrev_b32 v122, 1, v120
  v_lshl_add_u32 v121, v122, 8, v121
  v_and_b32 v120, 1, v120
  v_lshl_add_u32 v121, v120, 3, v121
  v_add_u32 v128, v121, v155
  v_lshl_add_u32 v130, v152, 4, s34
  s_mul_i32 s36, s28, 12288
  s_sub_u32 s37, s36, s34
  v_add_u32 v124, s37, v124
  v_add_u32 v125, s37, v125
  v_add_u32 v126, s37, v126
  v_add_u32 v127, s37, v127
  v_add_u32 v128, s37, v128
  v_lshl_add_u32 v131, v152, 4, s36
  v_mov_b32 v132, 0
  v_mov_b32 v133, 0
  v_mul_u32_u24 v120, 768, v154
  v_lshl_add_u32 v120, v153, 4, v120
  v_add_u32 v120, s36, v120
  s_barrier
  ds_write_b64 v120, v[132:133] offset:520
  ds_write_b64 v120, v[132:133] offset:3592
  ds_write_b64 v120, v[132:133] offset:6664
  ds_write_b64 v120, v[132:133] offset:9736
  s_mov_b32 s44, s50
  s_mov_b32 s45, s51
  v_pk_mul_f32 v[100:101], v[0:1], s[56:57]
  v_exp_f32 v100, v100 clamp
  v_exp_f32 v101, v101 clamp
  v_max_f32 v0, 0, v0
  v_max_f32 v1, 0, v1
  v_pk_add_f32 v[100:101], v[100:101], s[58:59]
  v_pk_add_f32 v[0:1], v[0:1], v[100:101]
  v_cvt_pk_bf16_f32 v80, v0, v1
  v_pk_mul_f32 v[100:101], v[2:3], s[56:57]
  v_exp_f32 v100, v100 clamp
  v_exp_f32 v101, v101 clamp
  v_max_f32 v2, 0, v2
  v_max_f32 v3, 0, v3
  v_pk_add_f32 v[100:101], v[100:101], s[58:59]
  v_pk_add_f32 v[2:3], v[2:3], v[100:101]
  v_cvt_pk_bf16_f32 v81, v2, v3
  ds_write_b64 v124, v[80:81] offset:0
  v_pk_mul_f32 v[102:103], v[16:17], s[56:57]
  v_exp_f32 v102, v102 clamp
  v_exp_f32 v103, v103 clamp
  v_max_f32 v16, 0, v16
  v_max_f32 v17, 0, v17
  v_pk_add_f32 v[102:103], v[102:103], s[58:59]
  v_pk_add_f32 v[16:17], v[16:17], v[102:103]
  v_cvt_pk_bf16_f32 v82, v16, v17
  v_pk_mul_f32 v[102:103], v[18:19], s[56:57]
  v_exp_f32 v102, v102 clamp
  v_exp_f32 v103, v103 clamp
  v_max_f32 v18, 0, v18
  v_max_f32 v19, 0, v19
  v_pk_add_f32 v[102:103], v[102:103], s[58:59]
  v_pk_add_f32 v[18:19], v[18:19], v[102:103]
  v_cvt_pk_bf16_f32 v83, v18, v19
  ds_write_b64 v125, v[82:83] offset:0
  v_pk_mul_f32 v[104:105], v[32:33], s[56:57]
  v_exp_f32 v104, v104 clamp
  v_exp_f32 v105, v105 clamp
  v_max_f32 v32, 0, v32
  v_max_f32 v33, 0, v33
  v_pk_add_f32 v[104:105], v[104:105], s[58:59]
  v_pk_add_f32 v[32:33], v[32:33], v[104:105]
  v_cvt_pk_bf16_f32 v84, v32, v33
  v_pk_mul_f32 v[104:105], v[34:35], s[56:57]
  v_exp_f32 v104, v104 clamp
  v_exp_f32 v105, v105 clamp
  v_max_f32 v34, 0, v34
  v_max_f32 v35, 0, v35
  v_pk_add_f32 v[104:105], v[104:105], s[58:59]
  v_pk_add_f32 v[34:35], v[34:35], v[104:105]
  v_cvt_pk_bf16_f32 v85, v34, v35
  ds_write_b64 v126, v[84:85] offset:0
  v_pk_mul_f32 v[106:107], v[48:49], s[56:57]
  v_exp_f32 v106, v106 clamp
  v_exp_f32 v107, v107 clamp
  v_max_f32 v48, 0, v48
  v_max_f32 v49, 0, v49
  v_pk_add_f32 v[106:107], v[106:107], s[58:59]
  v_pk_add_f32 v[48:49], v[48:49], v[106:107]
  v_cvt_pk_bf16_f32 v86, v48, v49
  v_pk_mul_f32 v[106:107], v[50:51], s[56:57]
  v_exp_f32 v106, v106 clamp
  v_exp_f32 v107, v107 clamp
  v_max_f32 v50, 0, v50
  v_max_f32 v51, 0, v51
  v_pk_add_f32 v[106:107], v[106:107], s[58:59]
  v_pk_add_f32 v[50:51], v[50:51], v[106:107]
  v_cvt_pk_bf16_f32 v87, v50, v51
  ds_write_b64 v127, v[86:87] offset:0
  v_pk_mul_f32 v[100:101], v[64:65], s[56:57]
  v_exp_f32 v100, v100 clamp
  v_exp_f32 v101, v101 clamp
  v_max_f32 v64, 0, v64
  v_max_f32 v65, 0, v65
  v_pk_add_f32 v[100:101], v[100:101], s[58:59]
  v_pk_add_f32 v[64:65], v[64:65], v[100:101]
  v_cvt_pk_bf16_f32 v88, v64, v65
  v_pk_mul_f32 v[100:101], v[66:67], s[56:57]
  v_exp_f32 v100, v100 clamp
  v_exp_f32 v101, v101 clamp
  v_max_f32 v66, 0, v66
  v_max_f32 v67, 0, v67
  v_pk_add_f32 v[100:101], v[100:101], s[58:59]
  v_pk_add_f32 v[66:67], v[66:67], v[100:101]
  v_cvt_pk_bf16_f32 v89, v66, v67
  ds_write_b64 v128, v[88:89] offset:0
  ds_read_b128 v[136:139], v131 offset:0
  ds_read_b128 v[140:143], v131 offset:1024
  ds_read_b128 v[144:147], v131 offset:2048
  v_pk_mul_f32 v[102:103], v[4:5], s[56:57]
  v_exp_f32 v102, v102 clamp
  v_exp_f32 v103, v103 clamp
  v_max_f32 v4, 0, v4
  v_max_f32 v5, 0, v5
  v_pk_add_f32 v[102:103], v[102:103], s[58:59]
  v_pk_add_f32 v[4:5], v[4:5], v[102:103]
  v_cvt_pk_bf16_f32 v90, v4, v5
  v_pk_mul_f32 v[102:103], v[6:7], s[56:57]
  v_exp_f32 v102, v102 clamp
  v_exp_f32 v103, v103 clamp
  v_max_f32 v6, 0, v6
  v_max_f32 v7, 0, v7
  v_pk_add_f32 v[102:103], v[102:103], s[58:59]
  v_pk_add_f32 v[6:7], v[6:7], v[102:103]
  v_cvt_pk_bf16_f32 v91, v6, v7
  ds_write_b64 v124, v[90:91] offset:3072
  v_pk_mul_f32 v[104:105], v[20:21], s[56:57]
  v_exp_f32 v104, v104 clamp
  v_exp_f32 v105, v105 clamp
  v_max_f32 v20, 0, v20
  v_max_f32 v21, 0, v21
  v_pk_add_f32 v[104:105], v[104:105], s[58:59]
  v_pk_add_f32 v[20:21], v[20:21], v[104:105]
  v_cvt_pk_bf16_f32 v92, v20, v21
  v_pk_mul_f32 v[104:105], v[22:23], s[56:57]
  v_exp_f32 v104, v104 clamp
  v_exp_f32 v105, v105 clamp
  v_max_f32 v22, 0, v22
  v_max_f32 v23, 0, v23
  v_pk_add_f32 v[104:105], v[104:105], s[58:59]
  v_pk_add_f32 v[22:23], v[22:23], v[104:105]
  v_cvt_pk_bf16_f32 v93, v22, v23
  ds_write_b64 v125, v[92:93] offset:3072
  s_waitcnt lgkmcnt(2)
  global_store_dwordx4 v130, v[136:139], s[44:45] offset:0 sc0 sc1
  global_store_dwordx4 v130, v[140:143], s[44:45] offset:1024 sc0 sc1
  global_store_dwordx4 v130, v[144:147], s[44:45] offset:2048 sc0 sc1
  s_add_u32 s44, s44, 24576
  s_addc_u32 s45, s45, 0
  v_pk_mul_f32 v[106:107], v[36:37], s[56:57]
  v_exp_f32 v106, v106 clamp
  v_exp_f32 v107, v107 clamp
  v_max_f32 v36, 0, v36
  v_max_f32 v37, 0, v37
  v_pk_add_f32 v[106:107], v[106:107], s[58:59]
  v_pk_add_f32 v[36:37], v[36:37], v[106:107]
  v_cvt_pk_bf16_f32 v94, v36, v37
  v_pk_mul_f32 v[106:107], v[38:39], s[56:57]
  v_exp_f32 v106, v106 clamp
  v_exp_f32 v107, v107 clamp
  v_max_f32 v38, 0, v38
  v_max_f32 v39, 0, v39
  v_pk_add_f32 v[106:107], v[106:107], s[58:59]
  v_pk_add_f32 v[38:39], v[38:39], v[106:107]
  v_cvt_pk_bf16_f32 v95, v38, v39
  ds_write_b64 v126, v[94:95] offset:3072
  v_pk_mul_f32 v[100:101], v[52:53], s[56:57]
  v_exp_f32 v100, v100 clamp
  v_exp_f32 v101, v101 clamp
  v_max_f32 v52, 0, v52
  v_max_f32 v53, 0, v53
  v_pk_add_f32 v[100:101], v[100:101], s[58:59]
  v_pk_add_f32 v[52:53], v[52:53], v[100:101]
  v_cvt_pk_bf16_f32 v80, v52, v53
  v_pk_mul_f32 v[100:101], v[54:55], s[56:57]
  v_exp_f32 v100, v100 clamp
  v_exp_f32 v101, v101 clamp
  v_max_f32 v54, 0, v54
  v_max_f32 v55, 0, v55
  v_pk_add_f32 v[100:101], v[100:101], s[58:59]
  v_pk_add_f32 v[54:55], v[54:55], v[100:101]
  v_cvt_pk_bf16_f32 v81, v54, v55
  ds_write_b64 v127, v[80:81] offset:3072
  v_pk_mul_f32 v[102:103], v[68:69], s[56:57]
  v_exp_f32 v102, v102 clamp
  v_exp_f32 v103, v103 clamp
  v_max_f32 v68, 0, v68
  v_max_f32 v69, 0, v69
  v_pk_add_f32 v[102:103], v[102:103], s[58:59]
  v_pk_add_f32 v[68:69], v[68:69], v[102:103]
  v_cvt_pk_bf16_f32 v82, v68, v69
  v_pk_mul_f32 v[102:103], v[70:71], s[56:57]
  v_exp_f32 v102, v102 clamp
  v_exp_f32 v103, v103 clamp
  v_max_f32 v70, 0, v70
  v_max_f32 v71, 0, v71
  v_pk_add_f32 v[102:103], v[102:103], s[58:59]
  v_pk_add_f32 v[70:71], v[70:71], v[102:103]
  v_cvt_pk_bf16_f32 v83, v70, v71
  ds_write_b64 v128, v[82:83] offset:3072
  ds_read_b128 v[136:139], v131 offset:3072
  ds_read_b128 v[140:143], v131 offset:4096
  ds_read_b128 v[144:147], v131 offset:5120
  s_waitcnt vmcnt(3)
L_u_pn_20:
  v_readfirstlane_b32 s52, v172
  s_nop 0
  s_cmp_lg_u32 s52, 0
  s_cbranch_scc1 L_u_go_21
  s_sleep 2
  s_add_u32 s93, s93, 1
  s_cmp_gt_u32 s93, 300000
  s_cbranch_scc1 L_u_go_21
  global_load_dword v172, v171, s[48:49] sc1
  s_waitcnt vmcnt(0)
  s_branch L_u_pn_20
L_u_go_21:
L_u_pl_22:
  v_cmp_ne_u32 vcc, s52, v170
  s_cbranch_vccz L_u_ok_23
  s_sleep 4
  s_add_u32 s93, s93, 1
  s_cmp_gt_u32 s93, 300000
  s_cbranch_scc1 L_u_ok_23
  global_load_dword v170, v169, s[50:51] sc1
  s_waitcnt vmcnt(0)
  s_branch L_u_pl_22
L_u_ok_23:
  global_load_dwordx4 v[160:163], v173, s[50:51] sc1
  global_load_dwordx4 v[164:167], v173, s[50:51] offset:16 sc1
  global_load_dword v168, v173, s[50:51] offset:-4 sc1
  v_pk_mul_f32 v[104:105], v[8:9], s[56:57]
  v_exp_f32 v104, v104 clamp
  v_exp_f32 v105, v105 clamp
  v_max_f32 v8, 0, v8
  v_max_f32 v9, 0, v9
  v_pk_add_f32 v[104:105], v[104:105], s[58:59]
  v_pk_add_f32 v[8:9], v[8:9], v[104:105]
  v_cvt_pk_bf16_f32 v84, v8, v9
  v_pk_mul_f32 v[104:105], v[10:11], s[56:57]
  v_exp_f32 v104, v104 clamp
  v_exp_f32 v105, v105 clamp
  v_max_f32 v10, 0, v10
  v_max_f32 v11, 0, v11
  v_pk_add_f32 v[104:105], v[104:105], s[58:59]
  v_pk_add_f32 v[10:11], v[10:11], v[104:105]
  v_cvt_pk_bf16_f32 v85, v10, v11
  ds_write_b64 v124, v[84:85] offset:6144
  v_pk_mul_f32 v[106:107], v[24:25], s[56:57]
  v_exp_f32 v106, v106 clamp
  v_exp_f32 v107, v107 clamp
  v_max_f32 v24, 0, v24
  v_max_f32 v25, 0, v25
  v_pk_add_f32 v[106:107], v[106:107], s[58:59]
  v_pk_add_f32 v[24:25], v[24:25], v[106:107]
  v_cvt_pk_bf16_f32 v86, v24, v25
  v_pk_mul_f32 v[106:107], v[26:27], s[56:57]
  v_exp_f32 v106, v106 clamp
  v_exp_f32 v107, v107 clamp
  v_max_f32 v26, 0, v26
  v_max_f32 v27, 0, v27
  v_pk_add_f32 v[106:107], v[106:107], s[58:59]
  v_pk_add_f32 v[26:27], v[26:27], v[106:107]
  v_cvt_pk_bf16_f32 v87, v26, v27
  ds_write_b64 v125, v[86:87] offset:6144
  s_waitcnt lgkmcnt(2)
  global_store_dwordx4 v130, v[136:139], s[44:45] offset:0 sc0 sc1
  global_store_dwordx4 v130, v[140:143], s[44:45] offset:1024 sc0 sc1
  global_store_dwordx4 v130, v[144:147], s[44:45] offset:2048 sc0 sc1
  s_add_u32 s44, s44, 24576
  s_addc_u32 s45, s45, 0
  v_pk_mul_f32 v[100:101], v[40:41], s[56:57]
  v_exp_f32 v100, v100 clamp
  v_exp_f32 v101, v101 clamp
  v_max_f32 v40, 0, v40
  v_max_f32 v41, 0, v41
  v_pk_add_f32 v[100:101], v[100:101], s[58:59]
  v_pk_add_f32 v[40:41], v[40:41], v[100:101]
  v_cvt_pk_bf16_f32 v88, v40, v41
  v_pk_mul_f32 v[100:101], v[42:43], s[56:57]
  v_exp_f32 v100, v100 clamp
  v_exp_f32 v101, v101 clamp
  v_max_f32 v42, 0, v42
  v_max_f32 v43, 0, v43
  v_pk_add_f32 v[100:101], v[100:101], s[58:59]
  v_pk_add_f32 v[42:43], v[42:43], v[100:101]
  v_cvt_pk_bf16_f32 v89, v42, v43
  ds_write_b64 v126, v[88:89] offset:6144
  v_pk_mul_f32 v[102:103], v[56:57], s[56:57]
  v_exp_f32 v102, v102 clamp
  v_exp_f32 v103, v103 clamp
  v_max_f32 v56, 0, v56
  v_max_f32 v57, 0, v57
  v_pk_add_f32 v[102:103], v[102:103], s[58:59]
  v_pk_add_f32 v[56:57], v[56:57], v[102:103]
  v_cvt_pk_bf16_f32 v90, v56, v57
  v_pk_mul_f32 v[102:103], v[58:59], s[56:57]
  v_exp_f32 v102, v102 clamp
  v_exp_f32 v103, v103 clamp
  v_max_f32 v58, 0, v58
  v_max_f32 v59, 0, v59
  v_pk_add_f32 v[102:103], v[102:103], s[58:59]
  v_pk_add_f32 v[58:59], v[58:59], v[102:103]
  v_cvt_pk_bf16_f32 v91, v58, v59
  ds_write_b64 v127, v[90:91] offset:6144
  v_pk_mul_f32 v[104:105], v[72:73], s[56:57]
  v_exp_f32 v104, v104 clamp
  v_exp_f32 v105, v105 clamp
  v_max_f32 v72, 0, v72
  v_max_f32 v73, 0, v73
  v_pk_add_f32 v[104:105], v[104:105], s[58:59]
  v_pk_add_f32 v[72:73], v[72:73], v[104:105]
  v_cvt_pk_bf16_f32 v92, v72, v73
  v_pk_mul_f32 v[104:105], v[74:75], s[56:57]
  v_exp_f32 v104, v104 clamp
  v_exp_f32 v105, v105 clamp
  v_max_f32 v74, 0, v74
  v_max_f32 v75, 0, v75
  v_pk_add_f32 v[104:105], v[104:105], s[58:59]
  v_pk_add_f32 v[74:75], v[74:75], v[104:105]
  v_cvt_pk_bf16_f32 v93, v74, v75
  ds_write_b64 v128, v[92:93] offset:6144
  ds_read_b128 v[136:139], v131 offset:6144
  ds_read_b128 v[140:143], v131 offset:7168
  ds_read_b128 v[144:147], v131 offset:8192
  v_pk_mul_f32 v[106:107], v[12:13], s[56:57]
  v_exp_f32 v106, v106 clamp
  v_exp_f32 v107, v107 clamp
  v_max_f32 v12, 0, v12
  v_max_f32 v13, 0, v13
  v_pk_add_f32 v[106:107], v[106:107], s[58:59]
  v_pk_add_f32 v[12:13], v[12:13], v[106:107]
  v_cvt_pk_bf16_f32 v94, v12, v13
  v_pk_mul_f32 v[106:107], v[14:15], s[56:57]
  v_exp_f32 v106, v106 clamp
  v_exp_f32 v107, v107 clamp
  v_max_f32 v14, 0, v14
  v_max_f32 v15, 0, v15
  v_pk_add_f32 v[106:107], v[106:107], s[58:59]
  v_pk_add_f32 v[14:15], v[14:15], v[106:107]
  v_cvt_pk_bf16_f32 v95, v14, v15
  ds_write_b64 v124, v[94:95] offset:9216
  v_pk_mul_f32 v[100:101], v[28:29], s[56:57]
  v_exp_f32 v100, v100 clamp
  v_exp_f32 v101, v101 clamp
  v_max_f32 v28, 0, v28
  v_max_f32 v29, 0, v29
  v_pk_add_f32 v[100:101], v[100:101], s[58:59]
  v_pk_add_f32 v[28:29], v[28:29], v[100:101]
  v_cvt_pk_bf16_f32 v80, v28, v29
  v_pk_mul_f32 v[100:101], v[30:31], s[56:57]
  v_exp_f32 v100, v100 clamp
  v_exp_f32 v101, v101 clamp
  v_max_f32 v30, 0, v30
  v_max_f32 v31, 0, v31
  v_pk_add_f32 v[100:101], v[100:101], s[58:59]
  v_pk_add_f32 v[30:31], v[30:31], v[100:101]
  v_cvt_pk_bf16_f32 v81, v30, v31
  ds_write_b64 v125, v[80:81] offset:9216
  s_waitcnt lgkmcnt(2)
  global_store_dwordx4 v130, v[136:139], s[44:45] offset:0 sc0 sc1
  global_store_dwordx4 v130, v[140:143], s[44:45] offset:1024 sc0 sc1
  global_store_dwordx4 v130, v[144:147], s[44:45] offset:2048 sc0 sc1
  s_add_u32 s44, s44, 24576
  s_addc_u32 s45, s45, 0
  v_pk_mul_f32 v[102:103], v[44:45], s[56:57]
  v_exp_f32 v102, v102 clamp
  v_exp_f32 v103, v103 clamp
  v_max_f32 v44, 0, v44
  v_max_f32 v45, 0, v45
  v_pk_add_f32 v[102:103], v[102:103], s[58:59]
  v_pk_add_f32 v[44:45], v[44:45], v[102:103]
  v_cvt_pk_bf16_f32 v82, v44, v45
  v_pk_mul_f32 v[102:103], v[46:47], s[56:57]
  v_exp_f32 v102, v102 clamp
  v_exp_f32 v103, v103 clamp
  v_max_f32 v46, 0, v46
  v_max_f32 v47, 0, v47
  v_pk_add_f32 v[102:103], v[102:103], s[58:59]
  v_pk_add_f32 v[46:47], v[46:47], v[102:103]
  v_cvt_pk_bf16_f32 v83, v46, v47
  ds_write_b64 v126, v[82:83] offset:9216
  v_pk_mul_f32 v[104:105], v[60:61], s[56:57]
  v_exp_f32 v104, v104 clamp
  v_exp_f32 v105, v105 clamp
  v_max_f32 v60, 0, v60
  v_max_f32 v61, 0, v61
  v_pk_add_f32 v[104:105], v[104:105], s[58:59]
  v_pk_add_f32 v[60:61], v[60:61], v[104:105]
  v_cvt_pk_bf16_f32 v84, v60, v61
  v_pk_mul_f32 v[104:105], v[62:63], s[56:57]
  v_exp_f32 v104, v104 clamp
  v_exp_f32 v105, v105 clamp
  v_max_f32 v62, 0, v62
  v_max_f32 v63, 0, v63
  v_pk_add_f32 v[104:105], v[104:105], s[58:59]
  v_pk_add_f32 v[62:63], v[62:63], v[104:105]
  v_cvt_pk_bf16_f32 v85, v62, v63
  ds_write_b64 v127, v[84:85] offset:9216
  v_pk_mul_f32 v[106:107], v[76:77], s[56:57]
  v_exp_f32 v106, v106 clamp
  v_exp_f32 v107, v107 clamp
  v_max_f32 v76, 0, v76
  v_max_f32 v77, 0, v77
  v_pk_add_f32 v[106:107], v[106:107], s[58:59]
  v_pk_add_f32 v[76:77], v[76:77], v[106:107]
  v_cvt_pk_bf16_f32 v86, v76, v77
  v_pk_mul_f32 v[106:107], v[78:79], s[56:57]
  v_exp_f32 v106, v106 clamp
  v_exp_f32 v107, v107 clamp
  v_max_f32 v78, 0, v78
  v_max_f32 v79, 0, v79
  v_pk_add_f32 v[106:107], v[106:107], s[58:59]
  v_pk_add_f32 v[78:79], v[78:79], v[106:107]
  v_cvt_pk_bf16_f32 v87, v78, v79
  ds_write_b64 v128, v[86:87] offset:9216
  ds_read_b128 v[136:139], v131 offset:9216
  ds_read_b128 v[140:143], v131 offset:10240
  ds_read_b128 v[144:147], v131 offset:11264
  s_waitcnt lgkmcnt(0)
  global_store_dwordx4 v130, v[136:139], s[44:45] offset:0 sc0 sc1
  global_store_dwordx4 v130, v[140:143], s[44:45] offset:1024 sc0 sc1
  global_store_dwordx4 v130, v[144:147], s[44:45] offset:2048 sc0 sc1
  s_branch L_g_fin_8
L_g_fin_8:
  s_lshl_b32 s88, s3, 3
  s_add_u32 s88, s88, s4
  s_lshl_b32 s88, s88, 2
  s_add_u32 s88, s88, 8130560
  s_lshl_b32 s30, s3, 2
  s_add_u32 s30, s30, s4
  s_lshl_b32 s30, s30, 2
  s_add_u32 s30, s30, 8131040
  s_cmp_ge_u32 s4, 8
  s_cselect_b32 s88, s30, s88
  s_branch L_conv
L_help:
  s_load_dwordx2 s[8:9], s[0:1], 0
  s_load_dwordx2 s[12:13], s[0:1], 80
  s_load_dwordx4 s[48:51], s[0:1], 112
  v_lshrrev_b32 v1, 6, v0
  s_nop 0
  v_readfirstlane_b32 s28, v1
  s_lshl_b32 s3, s6, 3
  s_add_u32 s3, s3, s5
  s_lshl_b32 s90, s3, 1
  s_add_u32 s90, s90, 1
  s_mov_b32 s91, 2
  s_mov_b32 s85, 113536
  s_mov_b32 s84, 0
  s_lshr_b32 s86, s5, 1
  s_lshl_b32 s86, s86, 2
  s_lshr_b32 s29, s6, 1
  s_add_u32 s86, s86, s29
  s_and_b32 s83, s5, 1
  s_lshl_b32 s83, s83, 1
  s_and_b32 s29, s6, 1
  s_add_u32 s83, s83, s29
  s_waitcnt lgkmcnt(0)
  s_mov_b32 s10, 2621440
  s_mov_b32 s11, 0x20000
  s_mov_b32 s14, 2457600
  s_mov_b32 s15, 0x20000
  s_cmp_lg_u32 s3, 0
  s_cbranch_scc1 L_pf
  s_memrealtime s[36:37]
  v_mov_b32 v110, 0
  v_cmp_eq_u32 vcc, 0, v0
  s_waitcnt lgkmcnt(0)
  s_or_b32 s36, s36, 1
  v_mov_b32 v111, s36
  s_and_saveexec_b64 s[34:35], vcc
  s_cbranch_execz L_nonce_24
  global_store_dword v110, v111, s[48:49] sc0 sc1
L_nonce_24:
  s_mov_b64 exec, s[34:35]
L_pf:
  v_mbcnt_lo_u32_b32 v240, -1, 0
  v_mbcnt_hi_u32_b32 v240, -1, v240
  s_lshl_b32 s80, s90, 9
  s_lshl_b32 s81, s28, 7
  s_add_u32 s80, s80, s81
  v_lshl_add_u32 v240, v240, 1, s80
  s_lshl_b32 s81, s90, 2
  s_lshr_b32 s82, s28, 1
  s_lshl_b32 s82, s82, 1
  s_add_u32 s81, s81, s82
  v_mov_b32 v241, s81
  global_load_ushort v232, v240, s[16:17]
  global_load_ushort v233, v240, s[18:19]
  global_load_ushort v234, v240, s[20:21]
  global_load_ushort v235, v240, s[22:23]
  global_load_ushort v236, v240, s[24:25]
  global_load_ushort v237, v240, s[26:27]
  global_load_ushort v238, v241, s[60:61]
  global_load_ushort v239, v241, s[62:63]
  s_sub_u32 s29, s90, 1
  v_mbcnt_lo_u32_b32 v240, -1, 0
  v_mbcnt_hi_u32_b32 v240, -1, v240
  s_lshl_b32 s80, s29, 9
  s_lshl_b32 s81, s28, 7
  s_add_u32 s80, s80, s81
  v_lshl_add_u32 v240, v240, 1, s80
  s_lshl_b32 s81, s29, 2
  s_lshr_b32 s82, s28, 1
  s_lshl_b32 s82, s82, 1
  s_add_u32 s81, s81, s82
  v_mov_b32 v241, s81
  global_load_ushort v224, v240, s[16:17]
  global_load_ushort v225, v240, s[18:19]
  global_load_ushort v226, v240, s[20:21]
  global_load_ushort v227, v240, s[22:23]
  global_load_ushort v228, v240, s[24:25]
  global_load_ushort v229, v240, s[26:27]
  global_load_ushort v230, v241, s[60:61]
  global_load_ushort v231, v241, s[62:63]
  s_load_dwordx2 s[56:57], s[0:1], 96
  v_and_b32 v1, 63, v0
  s_mul_i32 s31, s86, 163840
  s_mul_i32 s32, s83, 320
  s_add_u32 s31, s31, s32
  s_mul_i32 s33, s28, 672
  s_lshl_b32 s34, s33, 4
  v_add_u32 v4, s33, v1
  v_mul_u32_u24 v5, 3121, v4
  v_lshrrev_b32 v5, 16, v5
  v_mul_u32_u24 v6, 21, v5
  v_sub_u32 v4, v4, v6
  v_min_u32 v4, 19, v4
  v_mul_u32_u24 v5, 1280, v5
  v_lshl_add_u32 v5, v4, 4, v5
  s_add_u32 m0, s34, 0
  s_nop 0
  buffer_load_dwordx4 v5, s[8:11], s31 offen lds
  v_add_u32 v4, s33, v1
  v_add_u32 v4, 64, v4
  v_mul_u32_u24 v5, 3121, v4
  v_lshrrev_b32 v5, 16, v5
  v_mul_u32_u24 v6, 21, v5
  v_sub_u32 v4, v4, v6
  v_min_u32 v4, 19, v4
  v_mul_u32_u24 v5, 1280, v5
  v_lshl_add_u32 v5, v4, 4, v5
  s_add_u32 m0, s34, 1024
  s_nop 0
  buffer_load_dwordx4 v5, s[8:11], s31 offen lds
  v_add_u32 v4, s33, v1
  v_add_u32 v4, 128, v4
  v_mul_u32_u24 v5, 3121, v4
  v_lshrrev_b32 v5, 16, v5
  v_mul_u32_u24 v6, 21, v5
  v_sub_u32 v4, v4, v6
  v_min_u32 v4, 19, v4
  v_mul_u32_u24 v5, 1280, v5
  v_lshl_add_u32 v5, v4, 4, v5
  s_add_u32 m0, s34, 2048
  s_nop 0
  buffer_load_dwordx4 v5, s[8:11], s31 offen lds
  v_add_u32 v4, s33, v1
  v_add_u32 v4, 192, v4
  v_mul_u32_u24 v5, 3121, v4
  v_lshrrev_b32 v5, 16, v5
  v_mul_u32_u24 v6, 21, v5
  v_sub_u32 v4, v4, v6
  v_min_u32 v4, 19, v4
  v_mul_u32_u24 v5, 1280, v5
  v_lshl_add_u32 v5, v4, 4, v5
  s_add_u32 m0, s34, 3072
  s_nop 0
  buffer_load_dwordx4 v5, s[8:11], s31 offen lds
  v_add_u32 v4, s33, v1
  v_add_u32 v4, 256, v4
  v_mul_u32_u24 v5, 3121, v4
  v_lshrrev_b32 v5, 16, v5
  v_mul_u32_u24 v6, 21, v5
  v_sub_u32 v4, v4, v6
  v_min_u32 v4, 19, v4
  v_mul_u32_u24 v5, 1280, v5
  v_lshl_add_u32 v5, v4, 4, v5
  s_add_u32 m0, s34, 4096
  s_nop 0
  buffer_load_dwordx4 v5, s[8:11], s31 offen lds
  v_add_u32 v4, s33, v1
  v_add_u32 v4, 320, v4
  v_mul_u32_u24 v5, 3121, v4
  v_lshrrev_b32 v5, 16, v5
  v_mul_u32_u24 v6, 21, v5
  v_sub_u32 v4, v4, v6
  v_min_u32 v4, 19, v4
  v_mul_u32_u24 v5, 1280, v5
  v_lshl_add_u32 v5, v4, 4, v5
  s_add_u32 m0, s34, 5120
  s_nop 0
  buffer_load_dwordx4 v5, s[8:11], s31 offen lds
  v_add_u32 v4, s33, v1
  v_add_u32 v4, 384, v4
  v_mul_u32_u24 v5, 3121, v4
  v_lshrrev_b32 v5, 16, v5
  v_mul_u32_u24 v6, 21, v5
  v_sub_u32 v4, v4, v6
  v_min_u32 v4, 19, v4
  v_mul_u32_u24 v5, 1280, v5
  v_lshl_add_u32 v5, v4, 4, v5
  s_add_u32 m0, s34, 6144
  s_nop 0
  buffer_load_dwordx4 v5, s[8:11], s31 offen lds
  v_add_u32 v4, s33, v1
  v_add_u32 v4, 448, v4
  v_mul_u32_u24 v5, 3121, v4
  v_lshrrev_b32 v5, 16, v5
  v_mul_u32_u24 v6, 21, v5
  v_sub_u32 v4, v4, v6
  v_min_u32 v4, 19, v4
  v_mul_u32_u24 v5, 1280, v5
  v_lshl_add_u32 v5, v4, 4, v5
  s_add_u32 m0, s34, 7168
  s_nop 0
  buffer_load_dwordx4 v5, s[8:11], s31 offen lds
  v_add_u32 v4, s33, v1
  v_add_u32 v4, 512, v4
  v_mul_u32_u24 v5, 3121, v4
  v_lshrrev_b32 v5, 16, v5
  v_mul_u32_u24 v6, 21, v5
  v_sub_u32 v4, v4, v6
  v_min_u32 v4, 19, v4
  v_mul_u32_u24 v5, 1280, v5
  v_lshl_add_u32 v5, v4, 4, v5
  s_add_u32 m0, s34, 8192
  s_nop 0
  buffer_load_dwordx4 v5, s[8:11], s31 offen lds
  v_add_u32 v4, s33, v1
  v_add_u32 v4, 576, v4
  v_mul_u32_u24 v5, 3121, v4
  v_lshrrev_b32 v5, 16, v5
  v_mul_u32_u24 v6, 21, v5
  v_sub_u32 v4, v4, v6
  v_min_u32 v4, 19, v4
  v_mul_u32_u24 v5, 1280, v5
  v_lshl_add_u32 v5, v4, 4, v5
  s_add_u32 m0, s34, 9216
  s_nop 0
  buffer_load_dwordx4 v5, s[8:11], s31 offen lds
  v_add_u32 v4, s33, v1
  v_add_u32 v4, 640, v4
  v_mul_u32_u24 v5, 3121, v4
  v_lshrrev_b32 v5, 16, v5
  v_mul_u32_u24 v6, 21, v5
  v_sub_u32 v4, v4, v6
  v_min_u32 v4, 19, v4
  v_mul_u32_u24 v5, 1280, v5
  v_lshl_add_u32 v5, v4, 4, v5
  s_add_u32 m0, s34, 10240
  s_mov_b64 exec, 0xffffffff
  buffer_load_dwordx4 v5, s[8:11], s31 offen lds
  s_mov_b64 exec, -1
  v_and_b32 v2, 15, v1
  v_lshl_add_u32 v6, v2, 1, s32
  s_waitcnt lgkmcnt(0)
  global_load_ushort v176, v6, s[56:57] offset:0
  global_load_ushort v178, v6, s[56:57] offset:32
  global_load_ushort v180, v6, s[56:57] offset:64
  global_load_ushort v182, v6, s[56:57] offset:96
  global_load_ushort v184, v6, s[56:57] offset:128
  global_load_ushort v186, v6, s[56:57] offset:160
  global_load_ushort v188, v6, s[56:57] offset:192
  global_load_ushort v190, v6, s[56:57] offset:224
  global_load_ushort v192, v6, s[56:57] offset:256
  global_load_ushort v194, v6, s[56:57] offset:288
  s_and_b32 s39, s89, 1
  s_lshr_b32 s40, s89, 1
  s_mul_i32 s40, s40, 655360
  s_lshl_b32 s34, s87, 8
  v_and_b32 v123, 15, v0
  v_add_u32 v125, 10, v123
  v_add_u32 v126, 12, v123
  v_cmp_gt_u32 vcc, 8, v123
  s_nop 1
  v_cndmask_b32 v125, v126, v125, vcc
  v_add_u32 v126, 14, v123
  v_add_u32 v127, 7, v123
  v_cmp_gt_u32 vcc, 13, v123
  s_nop 1
  v_cndmask_b32 v126, v126, v127, vcc
  v_cmp_gt_u32 vcc, 10, v123
  s_nop 1
  v_cndmask_b32 v126, v126, v123, vcc
  s_cmp_eq_u32 s39, 0
  s_cselect_b64 vcc, -1, 0
  v_cndmask_b32 v125, v126, v125, vcc
  v_lshlrev_b32 v125, 7, v125
  v_add_u32 v120, s34, v0
  v_lshlrev_b32 v122, 7, v120
  v_add_u32 v122, s40, v122
  v_subrev_u32 v124, 5120, v120
  v_lshrrev_b32 v124, 4, v124
  v_mul_u32_u24 v124, 3840, v124
  v_add_u32 v124, v124, v125
  v_readfirstlane_b32 s29, v120
  s_nop 0
  s_cmp_ge_u32 s29, 5120
  s_cbranch_scc1 L_tb_25
  buffer_load_dword v200, v122, s[8:11], 0 offen
  s_branch L_te_26
L_tb_25:
  buffer_load_dword v200, v124, s[12:15], 0 offen
L_te_26:
  v_add_u32 v120, s34, v0
  v_add_u32 v120, 8192, v120
  v_min_u32 v120, 15359, v120
  v_lshlrev_b32 v122, 7, v120
  v_add_u32 v122, s40, v122
  v_subrev_u32 v124, 5120, v120
  v_lshrrev_b32 v124, 4, v124
  v_mul_u32_u24 v124, 3840, v124
  v_add_u32 v124, v124, v125
  v_readfirstlane_b32 s29, v120
  s_nop 0
  s_cmp_ge_u32 s29, 5120
  s_cbranch_scc1 L_tb_27
  buffer_load_dword v201, v122, s[8:11], 0 offen
  s_branch L_te_28
L_tb_27:
  buffer_load_dword v201, v124, s[12:15], 0 offen
L_te_28:
  s_waitcnt vmcnt(31)
L_kg:
  s_lshr_b32 s97, s28, 1
  s_and_b32 s98, s28, 1
  s_lshl_b32 s99, s90, 1
  s_add_u32 s99, s99, s97
  s_mul_i32 s95, s28, 4608
  s_add_u32 s95, s95, 17344
  s_add_u32 s95, s95, s85
  s_mul_i32 s94, s97, 4576
  s_add_u32 s94, s94, s85
  s_mul_i32 s96, s97, 8288
  s_add_u32 s96, s96, 17344
  s_add_u32 s96, s96, s85
  v_mbcnt_lo_u32_b32 v1, -1, 0
  v_mbcnt_hi_u32_b32 v1, -1, v1
  v_and_b32 v4, 15, v1
  v_lshrrev_b32 v5, 4, v1
  v_mov_b32 v6, 0
  v_mov_b32 v7, 0
  v_min_u32 v2, 59, v1
  v_lshl_add_u32 v2, v2, 3, s94
  ds_write_b64 v2, v[6:7] offset:4096
  v_lshl_add_u32 v6, v1, 2, s95
  v_add_u32 v7, 1152, v6
  v_add_u32 v8, 2304, v6
  v_add_u32 v9, 3456, v6
  v_mul_u32_u24 v10, 288, v4
  v_lshl_add_u32 v10, v5, 4, v10
  v_add_u32 v10, s95, v10
  s_lshl_b32 s100, s28, 11
  v_lshl_add_u32 v11, v1, 4, s100
  v_xor_b32 v12, 2048, v11
  s_add_u32 s100, s85, 9152
  v_add_u32 v11, s100, v11
  v_add_u32 v12, s100, v12
  s_mov_b32 s44, 1069066811
  s_mov_b32 s45, 849703008
  s_mov_b32 s46, 1060205080
  s_mov_b32 s47, 1042479491
  v_lshlrev_b32 v232, 16, v232
  v_lshlrev_b32 v233, 16, v233
  v_lshlrev_b32 v234, 16, v234
  v_lshlrev_b32 v235, 16, v235
  v_lshlrev_b32 v236, 16, v236
  v_lshlrev_b32 v237, 16, v237
  v_lshlrev_b32 v238, 16, v238
  v_lshlrev_b32 v239, 16, v239
  v_mul_f32 v2, s44, v238
  v_fma_f32 v3, v238, s44, -v2
  v_fma_f32 v3, v238, s45, v3
  v_exp_f32 v2, v2
  v_mul_f32 v3, s46, v3
  v_fma_f32 v2, v2, v3, v2
  v_cvt_pk_bf16_f32 v2, v2, v2
  v_lshlrev_b32 v238, 16, v2
  v_mul_f32 v232, v238, v232
  v_mul_f32 v233, v238, v233
  v_mul_f32 v232, s44, v232
  v_mul_f32 v233, s47, v233
  v_mul_f32 v234, v238, v234
  v_mul_f32 v235, v238, v235
  v_mul_f32 v14, v236, v234
  v_fma_f32 v14, -v237, v235, v14
  v_mul_f32 v15, v236, v235
  v_fma_f32 v15, v237, v234, v15
  v_mul_f32 v2, 1090519040, v232
  v_mul_f32 v3, 1090519040, v233
  v_exp_f32 v2, v2
  v_fract_f32 v3, v3
  v_cos_f32 v24, v3
  v_sin_f32 v25, v3
  v_mul_f32 v24, v2, v24
  v_mul_f32 v25, -v2, v25
  v_mov_b32 v26, 1.0
  v_mov_b32 v27, 0
  v_cvt_pk_bf16_f32 v13, v26, v27
  v_cvt_pk_bf16_f32 v16, v24, v25
  ds_write2_b32 v6, v13, v16 offset0:0 offset1:72
  v_pk_mul_f32 v[22:23], v[24:25], v[24:25] op_sel:[0,0] op_sel_hi:[1,0]
  v_pk_fma_f32 v[22:23], v[24:25], v[24:25], v[22:23] op_sel:[1,1,0] op_sel_hi:[0,1,1] neg_lo:[1,0,0]
  v_cvt_pk_bf16_f32 v17, v22, v23
  v_pk_mul_f32 v[20:21], v[22:23], v[24:25] op_sel:[0,0] op_sel_hi:[1,0]
  v_pk_fma_f32 v[20:21], v[22:23], v[24:25], v[20:21] op_sel:[1,1,0] op_sel_hi:[0,1,1] neg_lo:[1,0,0]
  v_cvt_pk_bf16_f32 v18, v20, v21
  ds_write2_b32 v6, v17, v18 offset0:144 offset1:216
  v_pk_mul_f32 v[22:23], v[20:21], v[24:25] op_sel:[0,0] op_sel_hi:[1,0]
  v_pk_fma_f32 v[22:23], v[20:21], v[24:25], v[22:23] op_sel:[1,1,0] op_sel_hi:[0,1,1] neg_lo:[1,0,0]
  v_cvt_pk_bf16_f32 v13, v22, v23
  v_pk_mul_f32 v[20:21], v[22:23], v[24:25] op_sel:[0,0] op_sel_hi:[1,0]
  v_pk_fma_f32 v[20:21], v[22:23], v[24:25], v[20:21] op_sel:[1,1,0] op_sel_hi:[0,1,1] neg_lo:[1,0,0]
  v_cvt_pk_bf16_f32 v16, v20, v21
  ds_write2_b32 v7, v13, v16 offset0:0 offset1:72
  v_pk_mul_f32 v[22:23], v[20:21], v[24:25] op_sel:[0,0] op_sel_hi:[1,0]
  v_pk_fma_f32 v[22:23], v[20:21], v[24:25], v[22:23] op_sel:[1,1,0] op_sel_hi:[0,1,1] neg_lo:[1,0,0]
  v_cvt_pk_bf16_f32 v17, v22, v23
  v_pk_mul_f32 v[20:21], v[22:23], v[24:25] op_sel:[0,0] op_sel_hi:[1,0]
  v_pk_fma_f32 v[20:21], v[22:23], v[24:25], v[20:21] op_sel:[1,1,0] op_sel_hi:[0,1,1] neg_lo:[1,0,0]
  v_cvt_pk_bf16_f32 v18, v20, v21
  ds_write2_b32 v7, v17, v18 offset0:144 offset1:216
  v_mul_f32 v2, 1115684864, v232
  v_mul_f32 v3, 1115684864, v233
  v_exp_f32 v2, v2
  v_fract_f32 v3, v3
  v_cos_f32 v26, v3
  v_sin_f32 v27, v3
  v_mul_f32 v26, v2, v26
  v_mul_f32 v27, -v2, v27
  v_cvt_pk_bf16_f32 v13, v26, v27
  v_pk_mul_f32 v[22:23], v[26:27], v[24:25] op_sel:[0,0] op_sel_hi:[1,0]
  v_pk_fma_f32 v[22:23], v[26:27], v[24:25], v[22:23] op_sel:[1,1,0] op_sel_hi:[0,1,1] neg_lo:[1,0,0]
  v_cvt_pk_bf16_f32 v16, v22, v23
  ds_write2_b32 v8, v13, v16 offset0:0 offset1:72
  v_pk_mul_f32 v[20:21], v[22:23], v[24:25] op_sel:[0,0] op_sel_hi:[1,0]
  v_pk_fma_f32 v[20:21], v[22:23], v[24:25], v[20:21] op_sel:[1,1,0] op_sel_hi:[0,1,1] neg_lo:[1,0,0]
  v_cvt_pk_bf16_f32 v17, v20, v21
  v_pk_mul_f32 v[22:23], v[20:21], v[24:25] op_sel:[0,0] op_sel_hi:[1,0]
  v_pk_fma_f32 v[22:23], v[20:21], v[24:25], v[22:23] op_sel:[1,1,0] op_sel_hi:[0,1,1] neg_lo:[1,0,0]
  v_cvt_pk_bf16_f32 v18, v22, v23
  ds_write2_b32 v8, v17, v18 offset0:144 offset1:216
  v_pk_mul_f32 v[20:21], v[22:23], v[24:25] op_sel:[0,0] op_sel_hi:[1,0]
  v_pk_fma_f32 v[20:21], v[22:23], v[24:25], v[20:21] op_sel:[1,1,0] op_sel_hi:[0,1,1] neg_lo:[1,0,0]
  v_cvt_pk_bf16_f32 v13, v20, v21
  v_pk_mul_f32 v[22:23], v[20:21], v[24:25] op_sel:[0,0] op_sel_hi:[1,0]
  v_pk_fma_f32 v[22:23], v[20:21], v[24:25], v[22:23] op_sel:[1,1,0] op_sel_hi:[0,1,1] neg_lo:[1,0,0]
  v_cvt_pk_bf16_f32 v16, v22, v23
  ds_write2_b32 v9, v13, v16 offset0:0 offset1:72
  v_pk_mul_f32 v[20:21], v[22:23], v[24:25] op_sel:[0,0] op_sel_hi:[1,0]
  v_pk_fma_f32 v[20:21], v[22:23], v[24:25], v[20:21] op_sel:[1,1,0] op_sel_hi:[0,1,1] neg_lo:[1,0,0]
  v_cvt_pk_bf16_f32 v17, v20, v21
  v_pk_mul_f32 v[22:23], v[20:21], v[24:25] op_sel:[0,0] op_sel_hi:[1,0]
  v_pk_fma_f32 v[22:23], v[20:21], v[24:25], v[22:23] op_sel:[1,1,0] op_sel_hi:[0,1,1] neg_lo:[1,0,0]
  v_cvt_pk_bf16_f32 v18, v22, v23
  ds_write2_b32 v9, v17, v18 offset0:144 offset1:216
  ds_read_b128 v[24:27], v10 offset:0
  ds_read_b128 v[28:31], v10 offset:64
  ds_read_b128 v[32:35], v10 offset:128
  ds_read_b128 v[36:39], v10 offset:192
  v_mul_f32 v2, 1124073472, v232
  v_mul_f32 v3, 1124073472, v233
  v_exp_f32 v2, v2
  v_fract_f32 v3, v3
  v_cos_f32 v68, v3
  v_sin_f32 v69, v3
  v_mul_f32 v68, v2, v68
  v_mul_f32 v69, v2, v69
  v_mul_f32 v2, 1140850688, v232
  v_mul_f32 v3, 1140850688, v233
  v_exp_f32 v2, v2
  v_fract_f32 v3, v3
  v_cos_f32 v70, v3
  v_sin_f32 v71, v3
  v_mul_f32 v70, v2, v70
  v_mul_f32 v71, v2, v71
  v_pk_mul_f32 v[72:73], v[14:15], v[68:69] op_sel:[0,0] op_sel_hi:[1,0]
  v_pk_fma_f32 v[72:73], v[14:15], v[68:69], v[72:73] op_sel:[1,1,0] op_sel_hi:[0,1,1] neg_lo:[1,0,0]
  v_pk_mul_f32 v[74:75], v[72:73], v[68:69] op_sel:[0,0] op_sel_hi:[1,0]
  v_pk_fma_f32 v[74:75], v[72:73], v[68:69], v[74:75] op_sel:[1,1,0] op_sel_hi:[0,1,1] neg_lo:[1,0,0]
  v_pk_mul_f32 v[76:77], v[74:75], v[68:69] op_sel:[0,0] op_sel_hi:[1,0]
  v_pk_fma_f32 v[76:77], v[74:75], v[68:69], v[76:77] op_sel:[1,1,0] op_sel_hi:[0,1,1] neg_lo:[1,0,0]
  v_pk_mul_f32 v[78:79], v[14:15], v[70:71] op_sel:[0,0] op_sel_hi:[1,0]
  v_pk_fma_f32 v[78:79], v[14:15], v[70:71], v[78:79] op_sel:[1,1,0] op_sel_hi:[0,1,1] neg_lo:[1,0,0]
  v_pk_mul_f32 v[80:81], v[72:73], v[70:71] op_sel:[0,0] op_sel_hi:[1,0]
  v_pk_fma_f32 v[80:81], v[72:73], v[70:71], v[80:81] op_sel:[1,1,0] op_sel_hi:[0,1,1] neg_lo:[1,0,0]
  v_pk_mul_f32 v[82:83], v[74:75], v[70:71] op_sel:[0,0] op_sel_hi:[1,0]
  v_pk_fma_f32 v[82:83], v[74:75], v[70:71], v[82:83] op_sel:[1,1,0] op_sel_hi:[0,1,1] neg_lo:[1,0,0]
  v_pk_mul_f32 v[84:85], v[76:77], v[70:71] op_sel:[0,0] op_sel_hi:[1,0]
  v_pk_fma_f32 v[84:85], v[76:77], v[70:71], v[84:85] op_sel:[1,1,0] op_sel_hi:[0,1,1] neg_lo:[1,0,0]
  v_pk_mul_f32 v[86:87], v[78:79], v[70:71] op_sel:[0,0] op_sel_hi:[1,0]
  v_pk_fma_f32 v[86:87], v[78:79], v[70:71], v[86:87] op_sel:[1,1,0] op_sel_hi:[0,1,1] neg_lo:[1,0,0]
  v_pk_mul_f32 v[88:89], v[86:87], v[70:71] op_sel:[0,0] op_sel_hi:[1,0]
  v_pk_fma_f32 v[88:89], v[86:87], v[70:71], v[88:89] op_sel:[1,1,0] op_sel_hi:[0,1,1] neg_lo:[1,0,0]
  v_cvt_pk_bf16_f32 v13, v86, v87
  v_pk_mul_f32 v[22:23], v[86:87], v[68:69] op_sel:[0,0] op_sel_hi:[1,0]
  v_pk_fma_f32 v[22:23], v[86:87], v[68:69], v[22:23] op_sel:[1,1,0] op_sel_hi:[0,1,1] neg_lo:[1,0,0]
  v_cvt_pk_bf16_f32 v16, v22, v23
  ds_write2_b32 v6, v13, v16 offset0:0 offset1:72
  v_pk_mul_f32 v[20:21], v[22:23], v[68:69] op_sel:[0,0] op_sel_hi:[1,0]
  v_pk_fma_f32 v[20:21], v[22:23], v[68:69], v[20:21] op_sel:[1,1,0] op_sel_hi:[0,1,1] neg_lo:[1,0,0]
  v_cvt_pk_bf16_f32 v17, v20, v21
  v_pk_mul_f32 v[22:23], v[20:21], v[68:69] op_sel:[0,0] op_sel_hi:[1,0]
  v_pk_fma_f32 v[22:23], v[20:21], v[68:69], v[22:23] op_sel:[1,1,0] op_sel_hi:[0,1,1] neg_lo:[1,0,0]
  v_cvt_pk_bf16_f32 v18, v22, v23
  ds_write2_b32 v7, v17, v18 offset0:0 offset1:72
  v_cvt_pk_bf16_f32 v13, v88, v89
  v_pk_mul_f32 v[22:23], v[88:89], v[68:69] op_sel:[0,0] op_sel_hi:[1,0]
  v_pk_fma_f32 v[22:23], v[88:89], v[68:69], v[22:23] op_sel:[1,1,0] op_sel_hi:[0,1,1] neg_lo:[1,0,0]
  v_cvt_pk_bf16_f32 v16, v22, v23
  ds_write2_b32 v8, v13, v16 offset0:0 offset1:72
  v_pk_mul_f32 v[20:21], v[22:23], v[68:69] op_sel:[0,0] op_sel_hi:[1,0]
  v_pk_fma_f32 v[20:21], v[22:23], v[68:69], v[20:21] op_sel:[1,1,0] op_sel_hi:[0,1,1] neg_lo:[1,0,0]
  v_cvt_pk_bf16_f32 v17, v20, v21
  v_pk_mul_f32 v[22:23], v[20:21], v[68:69] op_sel:[0,0] op_sel_hi:[1,0]
  v_pk_fma_f32 v[22:23], v[20:21], v[68:69], v[22:23] op_sel:[1,1,0] op_sel_hi:[0,1,1] neg_lo:[1,0,0]
  v_cvt_pk_bf16_f32 v18, v22, v23
  ds_write2_b32 v9, v17, v18 offset0:0 offset1:72
  v_pk_mul_f32 v[20:21], v[22:23], v[68:69] op_sel:[0,0] op_sel_hi:[1,0]
  v_pk_fma_f32 v[20:21], v[22:23], v[68:69], v[20:21] op_sel:[1,1,0] op_sel_hi:[0,1,1] neg_lo:[1,0,0]
  v_cvt_pk_bf16_f32 v13, v20, v21
  ds_write_b32 v6, v13 offset:576
  ds_read_b128 v[40:43], v10 offset:0
  ds_read_b128 v[44:47], v10 offset:64
  ds_read_b128 v[48:51], v10 offset:128
  ds_read_b128 v[52:55], v10 offset:192
  v_exp_f32 v2, v232
  v_fract_f32 v3, v233
  v_cos_f32 v68, v3
  v_sin_f32 v69, v3
  v_mul_f32 v68, v2, v68
  v_mul_f32 v69, v2, v69
  v_pk_mul_f32 v[70:71], v[68:69], v[68:69] op_sel:[0,0] op_sel_hi:[1,0]
  v_pk_fma_f32 v[70:71], v[68:69], v[68:69], v[70:71] op_sel:[1,1,0] op_sel_hi:[0,1,1] neg_lo:[1,0,0]
  v_pk_mul_f32 v[86:87], v[70:71], v[70:71] op_sel:[0,0] op_sel_hi:[1,0]
  v_pk_fma_f32 v[86:87], v[70:71], v[70:71], v[86:87] op_sel:[1,1,0] op_sel_hi:[0,1,1] neg_lo:[1,0,0]
  s_waitcnt lgkmcnt(0)
  v_cvt_pk_bf16_f32 v16, v74, v75
  v_mfma_f32_16x16x32_bf16 v[64:67], v[40:43], v[24:27], 0
  v_pk_mul_f32 v[22:23], v[74:75], v[70:71] op_sel:[0,0] op_sel_hi:[1,0]
  v_pk_fma_f32 v[22:23], v[74:75], v[70:71], v[22:23] op_sel:[1,1,0] op_sel_hi:[0,1,1] neg_lo:[1,0,0]
  v_cvt_pk_bf16_f32 v17, v22, v23
  ds_write2_b32 v6, v16, v17 offset0:0 offset1:72
  v_mfma_f32_16x16x32_bf16 v[64:67], v[44:47], v[28:31], v[64:67]
  v_pk_mul_f32 v[20:21], v[22:23], v[70:71] op_sel:[0,0] op_sel_hi:[1,0]
  v_pk_fma_f32 v[20:21], v[22:23], v[70:71], v[20:21] op_sel:[1,1,0] op_sel_hi:[0,1,1] neg_lo:[1,0,0]
  v_cvt_pk_bf16_f32 v18, v20, v21
  v_mfma_f32_16x16x32_bf16 v[64:67], v[48:51], v[32:35], v[64:67]
  v_pk_mul_f32 v[22:23], v[20:21], v[70:71] op_sel:[0,0] op_sel_hi:[1,0]
  v_pk_fma_f32 v[22:23], v[20:21], v[70:71], v[22:23] op_sel:[1,1,0] op_sel_hi:[0,1,1] neg_lo:[1,0,0]
  v_cvt_pk_bf16_f32 v13, v22, v23
  ds_write2_b32 v7, v18, v13 offset0:0 offset1:72
  v_mfma_f32_16x16x32_bf16 v[64:67], v[52:55], v[36:39], v[64:67]
  v_cvt_pk_bf16_f32 v16, v76, v77
  v_pk_mul_f32 v[22:23], v[76:77], v[70:71] op_sel:[0,0] op_sel_hi:[1,0]
  v_pk_fma_f32 v[22:23], v[76:77], v[70:71], v[22:23] op_sel:[1,1,0] op_sel_hi:[0,1,1] neg_lo:[1,0,0]
  v_cvt_pk_bf16_f32 v17, v22, v23
  ds_write2_b32 v8, v16, v17 offset0:0 offset1:72
  v_pk_mul_f32 v[20:21], v[22:23], v[70:71] op_sel:[0,0] op_sel_hi:[1,0]
  v_pk_fma_f32 v[20:21], v[22:23], v[70:71], v[20:21] op_sel:[1,1,0] op_sel_hi:[0,1,1] neg_lo:[1,0,0]
  v_cvt_pk_bf16_f32 v18, v20, v21
  v_pk_mul_f32 v[22:23], v[20:21], v[70:71] op_sel:[0,0] op_sel_hi:[1,0]
  v_pk_fma_f32 v[22:23], v[20:21], v[70:71], v[22:23] op_sel:[1,1,0] op_sel_hi:[0,1,1] neg_lo:[1,0,0]
  v_cvt_pk_bf16_f32 v13, v22, v23
  ds_write2_b32 v9, v18, v13 offset0:0 offset1:72
  v_cvt_pk_bf16_f32 v16, v78, v79
  v_pk_mul_f32 v[22:23], v[78:79], v[86:87] op_sel:[0,0] op_sel_hi:[1,0]
  v_pk_fma_f32 v[22:23], v[78:79], v[86:87], v[22:23] op_sel:[1,1,0] op_sel_hi:[0,1,1] neg_lo:[1,0,0]
  v_cvt_pk_bf16_f32 v17, v22, v23
  ds_write2_b32 v6, v16, v17 offset0:144 offset1:216
  v_cvt_pk_bf16_f32 v18, v80, v81
  v_pk_mul_f32 v[22:23], v[80:81], v[86:87] op_sel:[0,0] op_sel_hi:[1,0]
  v_pk_fma_f32 v[22:23], v[80:81], v[86:87], v[22:23] op_sel:[1,1,0] op_sel_hi:[0,1,1] neg_lo:[1,0,0]
  v_cvt_pk_bf16_f32 v13, v22, v23
  ds_write2_b32 v7, v18, v13 offset0:144 offset1:216
  v_cvt_pk_bf16_f32 v16, v82, v83
  v_pk_mul_f32 v[22:23], v[82:83], v[86:87] op_sel:[0,0] op_sel_hi:[1,0]
  v_pk_fma_f32 v[22:23], v[82:83], v[86:87], v[22:23] op_sel:[1,1,0] op_sel_hi:[0,1,1] neg_lo:[1,0,0]
  v_cvt_pk_bf16_f32 v17, v22, v23
  ds_write2_b32 v8, v16, v17 offset0:144 offset1:216
  v_cvt_pk_bf16_f32 v18, v84, v85
  v_pk_mul_f32 v[22:23], v[84:85], v[86:87] op_sel:[0,0] op_sel_hi:[1,0]
  v_pk_fma_f32 v[22:23], v[84:85], v[86:87], v[22:23] op_sel:[1,1,0] op_sel_hi:[0,1,1] neg_lo:[1,0,0]
  v_cvt_pk_bf16_f32 v13, v22, v23
  ds_write2_b32 v9, v18, v13 offset0:144 offset1:216
  ds_read_b128 v[40:43], v10 offset:0
  ds_read_b128 v[44:47], v10 offset:64
  ds_read_b128 v[48:51], v10 offset:128
  ds_read_b128 v[52:55], v10 offset:192
  v_pk_mul_f32 v[88:89], v[14:15], v[68:69] op_sel:[0,0] op_sel_hi:[1,0]
  v_pk_fma_f32 v[88:89], v[14:15], v[68:69], v[88:89] op_sel:[1,1,0] op_sel_hi:[0,1,1] neg_lo:[1,0,0]
  v_pk_mul_f32 v[90:91], v[88:89], v[68:69] op_sel:[0,0] op_sel_hi:[1,0]
  v_pk_fma_f32 v[90:91], v[88:89], v[68:69], v[90:91] op_sel:[1,1,0] op_sel_hi:[0,1,1] neg_lo:[1,0,0]
  s_waitcnt lgkmcnt(0)
  v_cvt_pk_bf16_f32 v16, v14, v15
  v_mfma_f32_16x16x32_bf16 v[60:63], v[40:43], v[24:27], 0
  v_cvt_pk_bf16_f32 v17, v88, v89
  ds_write2_b32 v6, v16, v17 offset0:0 offset1:72
  v_mfma_f32_16x16x32_bf16 v[60:63], v[44:47], v[28:31], v[60:63]
  v_cvt_pk_bf16_f32 v18, v90, v91
  v_mfma_f32_16x16x32_bf16 v[60:63], v[48:51], v[32:35], v[60:63]
  v_pk_mul_f32 v[22:23], v[90:91], v[68:69] op_sel:[0,0] op_sel_hi:[1,0]
  v_pk_fma_f32 v[22:23], v[90:91], v[68:69], v[22:23] op_sel:[1,1,0] op_sel_hi:[0,1,1] neg_lo:[1,0,0]
  v_cvt_pk_bf16_f32 v13, v22, v23
  ds_write2_b32 v6, v18, v13 offset0:144 offset1:216
  v_mfma_f32_16x16x32_bf16 v[60:63], v[52:55], v[36:39], v[60:63]
  v_pk_mul_f32 v[20:21], v[22:23], v[68:69] op_sel:[0,0] op_sel_hi:[1,0]
  v_pk_fma_f32 v[20:21], v[22:23], v[68:69], v[20:21] op_sel:[1,1,0] op_sel_hi:[0,1,1] neg_lo:[1,0,0]
  v_cvt_pk_bf16_f32 v16, v20, v21
  v_pk_mul_f32 v[22:23], v[20:21], v[68:69] op_sel:[0,0] op_sel_hi:[1,0]
  v_pk_fma_f32 v[22:23], v[20:21], v[68:69], v[22:23] op_sel:[1,1,0] op_sel_hi:[0,1,1] neg_lo:[1,0,0]
  v_cvt_pk_bf16_f32 v17, v22, v23
  ds_write2_b32 v7, v16, v17 offset0:0 offset1:72
  v_pk_mul_f32 v[20:21], v[22:23], v[68:69] op_sel:[0,0] op_sel_hi:[1,0]
  v_pk_fma_f32 v[20:21], v[22:23], v[68:69], v[20:21] op_sel:[1,1,0] op_sel_hi:[0,1,1] neg_lo:[1,0,0]
  v_cvt_pk_bf16_f32 v18, v20, v21
  v_pk_mul_f32 v[22:23], v[20:21], v[68:69] op_sel:[0,0] op_sel_hi:[1,0]
  v_pk_fma_f32 v[22:23], v[20:21], v[68:69], v[22:23] op_sel:[1,1,0] op_sel_hi:[0,1,1] neg_lo:[1,0,0]
  v_cvt_pk_bf16_f32 v13, v22, v23
  ds_write2_b32 v7, v18, v13 offset0:144 offset1:216
  v_cvt_pk_bf16_f32 v16, v72, v73
  v_pk_mul_f32 v[22:23], v[72:73], v[68:69] op_sel:[0,0] op_sel_hi:[1,0]
  v_pk_fma_f32 v[22:23], v[72:73], v[68:69], v[22:23] op_sel:[1,1,0] op_sel_hi:[0,1,1] neg_lo:[1,0,0]
  v_cvt_pk_bf16_f32 v17, v22, v23
  ds_write2_b32 v8, v16, v17 offset0:0 offset1:72
  v_pk_mul_f32 v[20:21], v[22:23], v[68:69] op_sel:[0,0] op_sel_hi:[1,0]
  v_pk_fma_f32 v[20:21], v[22:23], v[68:69], v[20:21] op_sel:[1,1,0] op_sel_hi:[0,1,1] neg_lo:[1,0,0]
  v_cvt_pk_bf16_f32 v18, v20, v21
  v_pk_mul_f32 v[22:23], v[20:21], v[68:69] op_sel:[0,0] op_sel_hi:[1,0]
  v_pk_fma_f32 v[22:23], v[20:21], v[68:69], v[22:23] op_sel:[1,1,0] op_sel_hi:[0,1,1] neg_lo:[1,0,0]
  v_cvt_pk_bf16_f32 v13, v22, v23
  ds_write2_b32 v8, v18, v13 offset0:144 offset1:216
  v_pk_mul_f32 v[20:21], v[22:23], v[68:69] op_sel:[0,0] op_sel_hi:[1,0]
  v_pk_fma_f32 v[20:21], v[22:23], v[68:69], v[20:21] op_sel:[1,1,0] op_sel_hi:[0,1,1] neg_lo:[1,0,0]
  v_cvt_pk_bf16_f32 v16, v20, v21
  v_pk_mul_f32 v[22:23], v[20:21], v[68:69] op_sel:[0,0] op_sel_hi:[1,0]
  v_pk_fma_f32 v[22:23], v[20:21], v[68:69], v[22:23] op_sel:[1,1,0] op_sel_hi:[0,1,1] neg_lo:[1,0,0]
  v_cvt_pk_bf16_f32 v17, v22, v23
  ds_write2_b32 v9, v16, v17 offset0:0 offset1:72
  v_pk_mul_f32 v[20:21], v[22:23], v[68:69] op_sel:[0,0] op_sel_hi:[1,0]
  v_pk_fma_f32 v[20:21], v[22:23], v[68:69], v[20:21] op_sel:[1,1,0] op_sel_hi:[0,1,1] neg_lo:[1,0,0]
  v_cvt_pk_bf16_f32 v18, v20, v21
  v_pk_mul_f32 v[22:23], v[20:21], v[68:69] op_sel:[0,0] op_sel_hi:[1,0]
  v_pk_fma_f32 v[22:23], v[20:21], v[68:69], v[22:23] op_sel:[1,1,0] op_sel_hi:[0,1,1] neg_lo:[1,0,0]
  v_cvt_pk_bf16_f32 v13, v22, v23
  ds_write2_b32 v9, v18, v13 offset0:144 offset1:216
  ds_read_b128 v[40:43], v10 offset:0
  ds_read_b128 v[44:47], v10 offset:64
  ds_read_b128 v[48:51], v10 offset:128
  ds_read_b128 v[52:55], v10 offset:192
  v_lshrrev_b32 v2, 1, v5
  v_lshlrev_b32 v2, 8, v2
  v_and_b32 v3, 1, v5
  v_lshl_add_u32 v2, v3, 3, v2
  v_lshl_add_u32 v2, v4, 4, v2
  v_sub_u32 v2, s94, v2
  v_add_u32 v19, 4088, v2
  v_add_u32 v95, 3578, v2
  v_lshlrev_b32 v2, 9, v5
  v_lshl_add_u32 v2, v4, 4, v2
  v_sub_u32 v92, s94, v2
  v_add_u32 v92, 1784, v92
  v_and_b32 v3, 1, v4
  v_lshl_add_u32 v93, v3, 1, v92
  v_subrev_u32 v93, 2, v93
  v_lshlrev_b32 v2, 8, v5
  v_lshl_add_u32 v2, v4, 4, v2
  v_sub_u32 v94, s94, v2
  v_add_u32 v94, 3060, v94
  v_cmp_eq_u32 vcc, 0, v1
  v_add_u32 v96, 6, v95
  v_add_u32 v2, 2, v95
  v_cndmask_b32 v96, v96, v2, vcc
  s_waitcnt lgkmcnt(0)
  v_mfma_f32_16x16x32_bf16 v[56:59], v[40:43], v[24:27], 0
  v_mfma_f32_16x16x32_bf16 v[56:59], v[44:47], v[28:31], v[56:59]
  v_mfma_f32_16x16x32_bf16 v[56:59], v[48:51], v[32:35], v[56:59]
  v_mfma_f32_16x16x32_bf16 v[56:59], v[52:55], v[36:39], v[56:59]
  s_cmp_eq_u32 s98, 1
  s_nop 6
  s_cbranch_scc1 L_k_h1_29
  ds_write_b128 v11, v[60:63]
  ds_write_b128 v11, v[64:67] offset:1024
  s_waitcnt lgkmcnt(0)
  s_barrier
  ds_read_b128 v[40:43], v12
  s_waitcnt lgkmcnt(0)
  v_pk_add_f32 v[40:41], v[40:41], v[56:57]
  v_pk_add_f32 v[42:43], v[42:43], v[58:59]
  v_cvt_pk_bf16_f32 v44, v43, v42
  v_cvt_pk_bf16_f32 v45, v41, v40
  ds_write_b64 v19, v[44:45]
  s_branch L_k_j_30
L_k_h1_29:
  ds_write_b128 v11, v[56:59]
  s_waitcnt lgkmcnt(0)
  s_barrier
  ds_read_b128 v[40:43], v12
  ds_read_b128 v[44:47], v12 offset:1024
  s_waitcnt lgkmcnt(0)
  v_pk_add_f32 v[40:41], v[40:41], v[60:61]
  v_pk_add_f32 v[44:45], v[44:45], v[64:65]
  v_pk_add_f32 v[42:43], v[42:43], v[62:63]
  v_pk_add_f32 v[46:47], v[46:47], v[66:67]
  v_cvt_pk_bf16_f32 v48, v44, v44
  v_mov_b32 v49, v48
  v_cvt_pk_bf16_f32 v50, v45, v45
  v_mov_b32 v51, v50
  v_cvt_pk_bf16_f32 v52, v46, v46
  v_mov_b32 v53, v52
  ds_write2_b64 v92, v[48:49], v[48:49] offset0:32 offset1:33
  ds_write2_b64 v92, v[50:51], v[50:51] offset0:0 offset1:1
  v_mov_b32 v2, s94
  s_mov_b64 exec, 1
  ds_write_b64 v2, v[52:53]
  s_mov_b64 exec, -1
  ds_write_b16 v93, v48 offset:256
  ds_write_b16 v93, v50
  v_cvt_pk_bf16_f32 v24, v43, v43
  v_cvt_pk_bf16_f32 v25, v43, v42
  v_cvt_pk_bf16_f32 v26, v42, v42
  ds_write2_b32 v94, v24, v25 offset0:0 offset1:1
  ds_write2_b32 v94, v26, v26 offset0:2 offset1:3
  v_cvt_pk_bf16_f32 v28, v41, v41
  v_cvt_pk_bf16_f32 v29, v40, v40
  ds_write_b16 v95, v28
  ds_write_b32 v95, v29 offset:2
  ds_write_b16 v96, v29
L_k_j_30:
  v_mov_b32 v3, 0
  v_min_u32 v2, 7, v1
  v_lshl_add_u32 v2, v2, 2, s96
  ds_write_b32 v2, v3 offset:0
  v_min_u32 v2, 6, v1
  v_lshl_add_u32 v2, v2, 2, s96
  ds_write_b32 v2, v3 offset:4164
  s_waitcnt lgkmcnt(0)
  s_cmp_eq_u32 s84, 1
  s_cbranch_scc1 L_kdone
  v_mbcnt_lo_u32_b32 v1, -1, 0
  v_mbcnt_hi_u32_b32 v1, -1, v1
  v_and_b32 v2, 15, v1
  v_lshrrev_b32 v3, 4, v1
  v_lshrrev_b32 v4, 2, v2
  v_lshl_add_u32 v4, v3, 3, v4
  s_lshl_b32 s32, s28, 5
  v_add_u32 v4, s32, v4
  v_mul_u32_u24 v4, 336, v4
  v_and_b32 v5, 3, v2
  v_lshl_add_u32 v4, v5, 3, v4
  s_mul_i32 s31, s83, 655360
  s_lshl_b32 s32, s86, 8
  s_add_u32 s31, s31, s32
  s_lshl_b32 s32, s28, 6
  s_add_u32 s31, s31, s32
  s_add_u32 s31, s31, 2621440
  v_lshlrev_b32 v5, 12, v2
  v_lshl_add_u32 v5, v3, 4, v5
  v_add_u32 v5, s31, v5
  s_waitcnt vmcnt(0)
  ds_read_b64_tr_b16 v[8:9], v4 offset:0
  ds_read_b64_tr_b16 v[10:11], v4 offset:1344
  ds_read_b64_tr_b16 v[12:13], v4 offset:32
  ds_read_b64_tr_b16 v[14:15], v4 offset:1376
  ds_read_b64_tr_b16 v[16:17], v4 offset:64
  ds_read_b64_tr_b16 v[18:19], v4 offset:1408
  ds_read_b64_tr_b16 v[20:21], v4 offset:96
  ds_read_b64_tr_b16 v[22:23], v4 offset:1440
  ds_read_b64_tr_b16 v[24:25], v4 offset:128
  ds_read_b64_tr_b16 v[26:27], v4 offset:1472
  ds_read_b64_tr_b16 v[28:29], v4 offset:160
  ds_read_b64_tr_b16 v[30:31], v4 offset:1504
  ds_read_b64_tr_b16 v[32:33], v4 offset:192
  ds_read_b64_tr_b16 v[34:35], v4 offset:1536
  ds_read_b64_tr_b16 v[36:37], v4 offset:224
  ds_read_b64_tr_b16 v[38:39], v4 offset:1568
  ds_read_b64_tr_b16 v[40:41], v4 offset:256
  ds_read_b64_tr_b16 v[42:43], v4 offset:1600
  ds_read_b64_tr_b16 v[44:45], v4 offset:288
  ds_read_b64_tr_b16 v[46:47], v4 offset:1632
  s_waitcnt lgkmcnt(15)
  global_store_dwordx4 v5, v[8:11], s[50:51] sc0 sc1
  v_add_u32 v5, 65536, v5
  s_waitcnt lgkmcnt(15)
  global_store_dwordx4 v5, v[12:15], s[50:51] sc0 sc1
  v_add_u32 v5, 65536, v5
  s_waitcnt lgkmcnt(14)
  global_store_dwordx4 v5, v[16:19], s[50:51] sc0 sc1
  v_add_u32 v5, 65536, v5
  s_waitcnt lgkmcnt(12)
  global_store_dwordx4 v5, v[20:23], s[50:51] sc0 sc1
  v_add_u32 v5, 65536, v5
  s_waitcnt lgkmcnt(10)
  global_store_dwordx4 v5, v[24:27], s[50:51] sc0 sc1
  v_add_u32 v5, 65536, v5
  s_waitcnt lgkmcnt(8)
  global_store_dwordx4 v5, v[28:31], s[50:51] sc0 sc1
  v_add_u32 v5, 65536, v5
  s_waitcnt lgkmcnt(6)
  global_store_dwordx4 v5, v[32:35], s[50:51] sc0 sc1
  v_add_u32 v5, 65536, v5
  s_waitcnt lgkmcnt(4)
  global_store_dwordx4 v5, v[36:39], s[50:51] sc0 sc1
  v_add_u32 v5, 65536, v5
  s_waitcnt lgkmcnt(2)
  global_store_dwordx4 v5, v[40:43], s[50:51] sc0 sc1
  v_add_u32 v5, 65536, v5
  s_waitcnt lgkmcnt(0)
  global_store_dwordx4 v5, v[44:47], s[50:51] sc0 sc1
  v_lshlrev_b32 v176, 16, v176
  v_lshlrev_b32 v178, 16, v178
  v_lshlrev_b32 v180, 16, v180
  v_lshlrev_b32 v182, 16, v182
  v_lshlrev_b32 v184, 16, v184
  v_lshlrev_b32 v186, 16, v186
  v_lshlrev_b32 v188, 16, v188
  v_lshlrev_b32 v190, 16, v190
  v_lshlrev_b32 v192, 16, v192
  v_lshlrev_b32 v194, 16, v194
  v_lshlrev_b32 v110, 16, v8
  v_and_b32 v111, 0xffff0000, v8
  v_pk_mul_f32 v[100:101], v[110:111], v[176:177] op_sel:[0,0] op_sel_hi:[1,0]
  v_lshlrev_b32 v114, 16, v9
  v_and_b32 v115, 0xffff0000, v9
  v_pk_mul_f32 v[102:103], v[114:115], v[176:177] op_sel:[0,0] op_sel_hi:[1,0]
  v_lshlrev_b32 v110, 16, v10
  v_and_b32 v111, 0xffff0000, v10
  v_pk_mul_f32 v[104:105], v[110:111], v[176:177] op_sel:[0,0] op_sel_hi:[1,0]
  v_lshlrev_b32 v114, 16, v11
  v_and_b32 v115, 0xffff0000, v11
  v_pk_mul_f32 v[106:107], v[114:115], v[176:177] op_sel:[0,0] op_sel_hi:[1,0]
  v_lshlrev_b32 v110, 16, v12
  v_and_b32 v111, 0xffff0000, v12
  v_pk_fma_f32 v[100:101], v[110:111], v[178:179], v[100:101] op_sel:[0,0,0] op_sel_hi:[1,0,1]
  v_lshlrev_b32 v114, 16, v13
  v_and_b32 v115, 0xffff0000, v13
  v_pk_fma_f32 v[102:103], v[114:115], v[178:179], v[102:103] op_sel:[0,0,0] op_sel_hi:[1,0,1]
  v_lshlrev_b32 v110, 16, v14
  v_and_b32 v111, 0xffff0000, v14
  v_pk_fma_f32 v[104:105], v[110:111], v[178:179], v[104:105] op_sel:[0,0,0] op_sel_hi:[1,0,1]
  v_lshlrev_b32 v114, 16, v15
  v_and_b32 v115, 0xffff0000, v15
  v_pk_fma_f32 v[106:107], v[114:115], v[178:179], v[106:107] op_sel:[0,0,0] op_sel_hi:[1,0,1]
  v_lshlrev_b32 v110, 16, v16
  v_and_b32 v111, 0xffff0000, v16
  v_pk_fma_f32 v[100:101], v[110:111], v[180:181], v[100:101] op_sel:[0,0,0] op_sel_hi:[1,0,1]
  v_lshlrev_b32 v114, 16, v17
  v_and_b32 v115, 0xffff0000, v17
  v_pk_fma_f32 v[102:103], v[114:115], v[180:181], v[102:103] op_sel:[0,0,0] op_sel_hi:[1,0,1]
  v_lshlrev_b32 v110, 16, v18
  v_and_b32 v111, 0xffff0000, v18
  v_pk_fma_f32 v[104:105], v[110:111], v[180:181], v[104:105] op_sel:[0,0,0] op_sel_hi:[1,0,1]
  v_lshlrev_b32 v114, 16, v19
  v_and_b32 v115, 0xffff0000, v19
  v_pk_fma_f32 v[106:107], v[114:115], v[180:181], v[106:107] op_sel:[0,0,0] op_sel_hi:[1,0,1]
  v_lshlrev_b32 v110, 16, v20
  v_and_b32 v111, 0xffff0000, v20
  v_pk_fma_f32 v[100:101], v[110:111], v[182:183], v[100:101] op_sel:[0,0,0] op_sel_hi:[1,0,1]
  v_lshlrev_b32 v114, 16, v21
  v_and_b32 v115, 0xffff0000, v21
  v_pk_fma_f32 v[102:103], v[114:115], v[182:183], v[102:103] op_sel:[0,0,0] op_sel_hi:[1,0,1]
  v_lshlrev_b32 v110, 16, v22
  v_and_b32 v111, 0xffff0000, v22
  v_pk_fma_f32 v[104:105], v[110:111], v[182:183], v[104:105] op_sel:[0,0,0] op_sel_hi:[1,0,1]
  v_lshlrev_b32 v114, 16, v23
  v_and_b32 v115, 0xffff0000, v23
  v_pk_fma_f32 v[106:107], v[114:115], v[182:183], v[106:107] op_sel:[0,0,0] op_sel_hi:[1,0,1]
  v_lshlrev_b32 v110, 16, v24
  v_and_b32 v111, 0xffff0000, v24
  v_pk_fma_f32 v[100:101], v[110:111], v[184:185], v[100:101] op_sel:[0,0,0] op_sel_hi:[1,0,1]
  v_lshlrev_b32 v114, 16, v25
  v_and_b32 v115, 0xffff0000, v25
  v_pk_fma_f32 v[102:103], v[114:115], v[184:185], v[102:103] op_sel:[0,0,0] op_sel_hi:[1,0,1]
  v_lshlrev_b32 v110, 16, v26
  v_and_b32 v111, 0xffff0000, v26
  v_pk_fma_f32 v[104:105], v[110:111], v[184:185], v[104:105] op_sel:[0,0,0] op_sel_hi:[1,0,1]
  v_lshlrev_b32 v114, 16, v27
  v_and_b32 v115, 0xffff0000, v27
  v_pk_fma_f32 v[106:107], v[114:115], v[184:185], v[106:107] op_sel:[0,0,0] op_sel_hi:[1,0,1]
  v_lshlrev_b32 v110, 16, v28
  v_and_b32 v111, 0xffff0000, v28
  v_pk_fma_f32 v[100:101], v[110:111], v[186:187], v[100:101] op_sel:[0,0,0] op_sel_hi:[1,0,1]
  v_lshlrev_b32 v114, 16, v29
  v_and_b32 v115, 0xffff0000, v29
  v_pk_fma_f32 v[102:103], v[114:115], v[186:187], v[102:103] op_sel:[0,0,0] op_sel_hi:[1,0,1]
  v_lshlrev_b32 v110, 16, v30
  v_and_b32 v111, 0xffff0000, v30
  v_pk_fma_f32 v[104:105], v[110:111], v[186:187], v[104:105] op_sel:[0,0,0] op_sel_hi:[1,0,1]
  v_lshlrev_b32 v114, 16, v31
  v_and_b32 v115, 0xffff0000, v31
  v_pk_fma_f32 v[106:107], v[114:115], v[186:187], v[106:107] op_sel:[0,0,0] op_sel_hi:[1,0,1]
  v_lshlrev_b32 v110, 16, v32
  v_and_b32 v111, 0xffff0000, v32
  v_pk_fma_f32 v[100:101], v[110:111], v[188:189], v[100:101] op_sel:[0,0,0] op_sel_hi:[1,0,1]
  v_lshlrev_b32 v114, 16, v33
  v_and_b32 v115, 0xffff0000, v33
  v_pk_fma_f32 v[102:103], v[114:115], v[188:189], v[102:103] op_sel:[0,0,0] op_sel_hi:[1,0,1]
  v_lshlrev_b32 v110, 16, v34
  v_and_b32 v111, 0xffff0000, v34
  v_pk_fma_f32 v[104:105], v[110:111], v[188:189], v[104:105] op_sel:[0,0,0] op_sel_hi:[1,0,1]
  v_lshlrev_b32 v114, 16, v35
  v_and_b32 v115, 0xffff0000, v35
  v_pk_fma_f32 v[106:107], v[114:115], v[188:189], v[106:107] op_sel:[0,0,0] op_sel_hi:[1,0,1]
  v_lshlrev_b32 v110, 16, v36
  v_and_b32 v111, 0xffff0000, v36
  v_pk_fma_f32 v[100:101], v[110:111], v[190:191], v[100:101] op_sel:[0,0,0] op_sel_hi:[1,0,1]
  v_lshlrev_b32 v114, 16, v37
  v_and_b32 v115, 0xffff0000, v37
  v_pk_fma_f32 v[102:103], v[114:115], v[190:191], v[102:103] op_sel:[0,0,0] op_sel_hi:[1,0,1]
  v_lshlrev_b32 v110, 16, v38
  v_and_b32 v111, 0xffff0000, v38
  v_pk_fma_f32 v[104:105], v[110:111], v[190:191], v[104:105] op_sel:[0,0,0] op_sel_hi:[1,0,1]
  v_lshlrev_b32 v114, 16, v39
  v_and_b32 v115, 0xffff0000, v39
  v_pk_fma_f32 v[106:107], v[114:115], v[190:191], v[106:107] op_sel:[0,0,0] op_sel_hi:[1,0,1]
  v_lshlrev_b32 v110, 16, v40
  v_and_b32 v111, 0xffff0000, v40
  v_pk_fma_f32 v[100:101], v[110:111], v[192:193], v[100:101] op_sel:[0,0,0] op_sel_hi:[1,0,1]
  v_lshlrev_b32 v114, 16, v41
  v_and_b32 v115, 0xffff0000, v41
  v_pk_fma_f32 v[102:103], v[114:115], v[192:193], v[102:103] op_sel:[0,0,0] op_sel_hi:[1,0,1]
  v_lshlrev_b32 v110, 16, v42
  v_and_b32 v111, 0xffff0000, v42
  v_pk_fma_f32 v[104:105], v[110:111], v[192:193], v[104:105] op_sel:[0,0,0] op_sel_hi:[1,0,1]
  v_lshlrev_b32 v114, 16, v43
  v_and_b32 v115, 0xffff0000, v43
  v_pk_fma_f32 v[106:107], v[114:115], v[192:193], v[106:107] op_sel:[0,0,0] op_sel_hi:[1,0,1]
  v_lshlrev_b32 v110, 16, v44
  v_and_b32 v111, 0xffff0000, v44
  v_pk_fma_f32 v[100:101], v[110:111], v[194:195], v[100:101] op_sel:[0,0,0] op_sel_hi:[1,0,1]
  v_lshlrev_b32 v114, 16, v45
  v_and_b32 v115, 0xffff0000, v45
  v_pk_fma_f32 v[102:103], v[114:115], v[194:195], v[102:103] op_sel:[0,0,0] op_sel_hi:[1,0,1]
  v_lshlrev_b32 v110, 16, v46
  v_and_b32 v111, 0xffff0000, v46
  v_pk_fma_f32 v[104:105], v[110:111], v[194:195], v[104:105] op_sel:[0,0,0] op_sel_hi:[1,0,1]
  v_lshlrev_b32 v114, 16, v47
  v_and_b32 v115, 0xffff0000, v47
  v_pk_fma_f32 v[106:107], v[114:115], v[194:195], v[106:107] op_sel:[0,0,0] op_sel_hi:[1,0,1]
  v_add_f32_dpp v100, v100, v100 quad_perm:[1,0,3,2] row_mask:0xf bank_mask:0xf
  v_add_f32_dpp v101, v101, v101 quad_perm:[1,0,3,2] row_mask:0xf bank_mask:0xf
  v_add_f32_dpp v102, v102, v102 quad_perm:[1,0,3,2] row_mask:0xf bank_mask:0xf
  v_add_f32_dpp v103, v103, v103 quad_perm:[1,0,3,2] row_mask:0xf bank_mask:0xf
  v_add_f32_dpp v104, v104, v104 quad_perm:[1,0,3,2] row_mask:0xf bank_mask:0xf
  v_add_f32_dpp v105, v105, v105 quad_perm:[1,0,3,2] row_mask:0xf bank_mask:0xf
  v_add_f32_dpp v106, v106, v106 quad_perm:[1,0,3,2] row_mask:0xf bank_mask:0xf
  v_add_f32_dpp v107, v107, v107 quad_perm:[1,0,3,2] row_mask:0xf bank_mask:0xf
  v_add_f32_dpp v100, v100, v100 quad_perm:[2,3,0,1] row_mask:0xf bank_mask:0xf
  v_add_f32_dpp v101, v101, v101 quad_perm:[2,3,0,1] row_mask:0xf bank_mask:0xf
  v_add_f32_dpp v102, v102, v102 quad_perm:[2,3,0,1] row_mask:0xf bank_mask:0xf
  v_add_f32_dpp v103, v103, v103 quad_perm:[2,3,0,1] row_mask:0xf bank_mask:0xf
  v_add_f32_dpp v104, v104, v104 quad_perm:[2,3,0,1] row_mask:0xf bank_mask:0xf
  v_add_f32_dpp v105, v105, v105 quad_perm:[2,3,0,1] row_mask:0xf bank_mask:0xf
  v_add_f32_dpp v106, v106, v106 quad_perm:[2,3,0,1] row_mask:0xf bank_mask:0xf
  v_add_f32_dpp v107, v107, v107 quad_perm:[2,3,0,1] row_mask:0xf bank_mask:0xf
  v_add_f32_dpp v100, v100, v100 row_half_mirror row_mask:0xf bank_mask:0xf
  v_add_f32_dpp v101, v101, v101 row_half_mirror row_mask:0xf bank_mask:0xf
  v_add_f32_dpp v102, v102, v102 row_half_mirror row_mask:0xf bank_mask:0xf
  v_add_f32_dpp v103, v103, v103 row_half_mirror row_mask:0xf bank_mask:0xf
  v_add_f32_dpp v104, v104, v104 row_half_mirror row_mask:0xf bank_mask:0xf
  v_add_f32_dpp v105, v105, v105 row_half_mirror row_mask:0xf bank_mask:0xf
  v_add_f32_dpp v106, v106, v106 row_half_mirror row_mask:0xf bank_mask:0xf
  v_add_f32_dpp v107, v107, v107 row_half_mirror row_mask:0xf bank_mask:0xf
  v_add_f32_dpp v100, v100, v100 row_mirror row_mask:0xf bank_mask:0xf
  v_add_f32_dpp v101, v101, v101 row_mirror row_mask:0xf bank_mask:0xf
  v_add_f32_dpp v102, v102, v102 row_mirror row_mask:0xf bank_mask:0xf
  v_add_f32_dpp v103, v103, v103 row_mirror row_mask:0xf bank_mask:0xf
  v_add_f32_dpp v104, v104, v104 row_mirror row_mask:0xf bank_mask:0xf
  v_add_f32_dpp v105, v105, v105 row_mirror row_mask:0xf bank_mask:0xf
  v_add_f32_dpp v106, v106, v106 row_mirror row_mask:0xf bank_mask:0xf
  v_add_f32_dpp v107, v107, v107 row_mirror row_mask:0xf bank_mask:0xf
  s_lshl_b32 s31, s83, 13
  s_lshl_b32 s32, s86, 9
  s_add_u32 s31, s31, s32
  s_lshl_b32 s32, s28, 7
  s_add_u32 s31, s31, s32
  s_add_u32 s31, s31, 7929856
  v_lshl_add_u32 v5, v3, 5, s31
  s_mov_b32 exec_lo, 0x00010001
  s_mov_b32 exec_hi, 0x00010001
  global_store_dwordx4 v5, v[100:103], s[50:51] sc0 sc1
  global_store_dwordx4 v5, v[104:107], s[50:51] offset:16 sc0 sc1
  s_mov_b64 exec, -1
  s_lshl_b32 s88, s83, 6
  s_lshl_b32 s30, s86, 2
  s_add_u32 s88, s88, s30
  s_add_u32 s88, s88, 8126464
  v_mov_b32 v120, 0
  global_load_dword v121, v120, s[48:49] sc1
  s_waitcnt vmcnt(0)
  s_barrier
  s_cmp_lg_u32 s28, 0
  s_cbranch_scc1 L_sig_31
  v_readfirstlane_b32 s52, v121
  s_nop 0
  s_cmp_lg_u32 s52, 0
  s_cbranch_scc1 L_sigk_32
  v_mov_b32 v120, 0
L_gn_33:
  global_load_dword v121, v120, s[48:49] sc1
  s_waitcnt vmcnt(0)
  v_readfirstlane_b32 s52, v121
  s_nop 0
  s_cmp_lg_u32 s52, 0
  s_cbranch_scc1 L_gno_34
  s_sleep 2
  s_add_u32 s93, s93, 1
  s_cmp_gt_u32 s93, 300000
  s_cbranch_scc1 L_gno_34
  s_branch L_gn_33
L_gno_34:
L_sigk_32:
  v_mov_b32 v120, s88
  v_mov_b32 v121, s52
  s_mov_b64 exec, 1
  global_store_dword v120, v121, s[50:51] sc0 sc1
  s_mov_b64 exec, -1
L_sig_31:
  s_cmp_lg_u32 s3, 63
  s_cbranch_scc1 L_nz
  s_load_dwordx4 s[48:51], s[0:1], 112
  v_lshlrev_b32 v1, 4, v0
  v_mov_b32 v4, 0
  v_mov_b32 v5, 0
  v_mov_b32 v6, 0
  v_mov_b32 v7, 0
  s_waitcnt lgkmcnt(0)
  s_add_u32 s44, s50, 7995392
  s_addc_u32 s45, s51, 0
  s_mov_b32 s46, 53760
  s_mov_b32 s47, 0x20000
  s_mov_b32 s34, 0
  buffer_store_dwordx4 v[4:7], v1, s[44:47], s34 offen sc0 sc1
  s_mov_b32 s34, 4096
  buffer_store_dwordx4 v[4:7], v1, s[44:47], s34 offen sc0 sc1
  s_mov_b32 s34, 8192
  buffer_store_dwordx4 v[4:7], v1, s[44:47], s34 offen sc0 sc1
  s_mov_b32 s34, 12288
  buffer_store_dwordx4 v[4:7], v1, s[44:47], s34 offen sc0 sc1
  s_mov_b32 s34, 16384
  buffer_store_dwordx4 v[4:7], v1, s[44:47], s34 offen sc0 sc1
  s_mov_b32 s34, 20480
  buffer_store_dwordx4 v[4:7], v1, s[44:47], s34 offen sc0 sc1
  s_mov_b32 s34, 24576
  buffer_store_dwordx4 v[4:7], v1, s[44:47], s34 offen sc0 sc1
  s_mov_b32 s34, 28672
  buffer_store_dwordx4 v[4:7], v1, s[44:47], s34 offen sc0 sc1
  s_mov_b32 s34, 32768
  buffer_store_dwordx4 v[4:7], v1, s[44:47], s34 offen sc0 sc1
  s_mov_b32 s34, 36864
  buffer_store_dwordx4 v[4:7], v1, s[44:47], s34 offen sc0 sc1
  s_mov_b32 s34, 40960
  buffer_store_dwordx4 v[4:7], v1, s[44:47], s34 offen sc0 sc1
  s_mov_b32 s34, 45056
  buffer_store_dwordx4 v[4:7], v1, s[44:47], s34 offen sc0 sc1
  s_mov_b32 s34, 49152
  buffer_store_dwordx4 v[4:7], v1, s[44:47], s34 offen sc0 sc1
  s_mov_b32 s34, 53248
  buffer_store_dwordx4 v[4:7], v1, s[44:47], s34 offen sc0 sc1
  s_waitcnt vmcnt(0)
  s_barrier
  v_mov_b32 v2, 4
  v_mov_b32 v3, 1
  v_cmp_eq_u32 vcc, 0, v0
  s_nop 0
  s_and_saveexec_b64 s[34:35], vcc
  s_cbranch_execz L_z_35
  global_store_dword v2, v3, s[48:49] sc0 sc1
L_z_35:
  s_mov_b64 exec, s[34:35]
L_nz:
  s_load_dwordx2 s[12:13], s[0:1], 88
  s_lshl_b32 s29, s87, 8
  v_add_u32 v245, s29, v0
  v_lshlrev_b32 v245, 7, v245
  s_mov_b32 s14, 819200
  s_mov_b32 s15, 0x20000
  s_waitcnt lgkmcnt(0)
  s_mov_b32 s29, 0
  buffer_load_dword v246, v245, s[12:15], s29 offen
  s_mov_b32 s29, 262144
  buffer_load_dword v247, v245, s[12:15], s29 offen
  s_mov_b32 s29, 524288
  buffer_load_dword v248, v245, s[12:15], s29 offen
  s_mov_b32 s29, 786432
  buffer_load_dword v249, v245, s[12:15], s29 offen
  v_mov_b32 v223, v239
  v_mov_b32 v232, v224
  v_mov_b32 v233, v225
  v_mov_b32 v234, v226
  v_mov_b32 v235, v227
  v_mov_b32 v236, v228
  v_mov_b32 v237, v229
  v_mov_b32 v238, v230
  v_mov_b32 v239, v231
  s_sub_u32 s90, s90, 1
  s_mov_b32 s85, 63232
  s_mov_b32 s84, 1
  s_branch L_kg
L_kdone:
  s_mov_b32 s88, 8138752
L_fc:
  v_mbcnt_lo_u32_b32 v174, -1, 0
  v_mbcnt_hi_u32_b32 v174, -1, v174
  s_mul_i32 s100, s90, 820
  s_lshr_b32 s100, s100, 16
  s_lshl_b32 s100, s100, 6
  s_add_u32 s100, s100, 8126464
  v_and_b32 v169, 15, v174
  v_lshl_add_u32 v169, v169, 2, s100
  v_mov_b32 v171, 0
  global_load_dword v172, v171, s[48:49] sc1
  global_load_dword v170, v169, s[50:51] sc1
  s_lshl_b32 s100, s98, 6
  v_add_u32 v174, s100, v174
  s_lshl_b32 s100, s99, 12
  s_add_u32 s100, s100, 2621440
  v_lshl_add_u32 v173, v174, 5, s100
  s_waitcnt vmcnt(0)
L_u_pn_36:
  v_readfirstlane_b32 s52, v172
  s_nop 0
  s_cmp_lg_u32 s52, 0
  s_cbranch_scc1 L_u_go_37
  s_sleep 2
  s_add_u32 s93, s93, 1
  s_cmp_gt_u32 s93, 300000
  s_cbranch_scc1 L_u_go_37
  global_load_dword v172, v171, s[48:49] sc1
  s_waitcnt vmcnt(0)
  s_branch L_u_pn_36
L_u_go_37:
L_u_pl_38:
  v_cmp_ne_u32 vcc, s52, v170
  s_cbranch_vccz L_u_ok_39
  s_sleep 4
  s_add_u32 s93, s93, 1
  s_cmp_gt_u32 s93, 300000
  s_cbranch_scc1 L_u_ok_39
  global_load_dword v170, v169, s[50:51] sc1
  s_waitcnt vmcnt(0)
  s_branch L_u_pl_38
L_u_ok_39:
  global_load_dwordx4 v[160:163], v173, s[50:51] sc1
  global_load_dwordx4 v[164:167], v173, s[50:51] offset:16 sc1
  global_load_dword v168, v173, s[50:51] offset:-4 sc1
L_conv:
  v_mbcnt_lo_u32_b32 v1, -1, 0
  v_mbcnt_hi_u32_b32 v1, -1, v1
  v_and_b32 v4, 15, v1
  v_lshrrev_b32 v5, 4, v1
  v_lshlrev_b32 v2, 5, v4
  v_lshlrev_b32 v3, 4, v5
  v_sub_u32 v6, v3, v2
  s_lshl_b32 s100, s98, 8
  s_add_u32 s101, s100, s94
  s_add_u32 s101, s101, 480
  v_add_u32 v6, s101, v6
  s_add_u32 s100, s100, s96
  v_lshlrev_b32 v2, 1, v4
  v_add_u32 v2, v2, v3
  v_and_b32 v3, 1, v4
  v_cmp_eq_u32 vcc, 0, v3
  v_mov_b32 v7, 2
  v_mov_b32 v8, 4164
  v_cndmask_b32 v7, v7, v8, vcc
  v_add3_u32 v7, v7, v2, s100
  v_add_u32 v8, 1024, v7
  v_add_u32 v9, 2048, v7
  v_add_u32 v10, 3072, v7
  v_cmp_eq_u32 vcc, 0, v174
  v_lshl_add_u32 v2, v174, 5, s96
  s_waitcnt vmcnt(0)
  v_cndmask_b32 v168, v168, 0, vcc
  ds_write_b128 v2, v[160:163] offset:32
  ds_write_b128 v2, v[164:167] offset:48
  v_alignbit_b32 v12, v160, v168, 16
  v_alignbit_b32 v13, v161, v160, 16
  v_alignbit_b32 v14, v162, v161, 16
  v_alignbit_b32 v15, v163, v162, 16
  v_alignbit_b32 v16, v164, v163, 16
  v_alignbit_b32 v17, v165, v164, 16
  v_alignbit_b32 v18, v166, v165, 16
  v_alignbit_b32 v19, v167, v166, 16
  ds_write_b128 v2, v[12:15] offset:4192
  ds_write_b128 v2, v[16:19] offset:4208
  s_waitcnt lgkmcnt(0)
  s_waitcnt vmcnt(0)
  s_barrier
  s_cmp_lg_u32 s28, 0
  s_cbranch_scc1 L_sig_40
  v_mov_b32 v2, s88
  v_mov_b32 v3, s52
  s_mov_b64 exec, 1
  global_store_dword v2, v3, s[50:51] sc0 sc1
  s_mov_b64 exec, -1
L_sig_40:
  s_lshr_b32 s29, s2, 3
  s_and_b32 s83, s29, 7
  s_load_dwordx2 s[12:13], s[0:1], 88
  v_mbcnt_lo_u32_b32 v11, -1, 0
  v_mbcnt_hi_u32_b32 v11, -1, v11
  s_mul_i32 s30, s83, 160
  v_add_u32 v12, 0, v11
  v_mul_u32_u24 v13, 6554, v12
  v_lshrrev_b32 v13, 16, v13
  v_mul_u32_u24 v14, 10, v13
  v_sub_u32 v12, v12, v14
  v_mul_u32_u24 v13, 1280, v13
  v_lshl_add_u32 v13, v12, 4, v13
  v_add_u32 v15, s30, v13
  v_add_u32 v12, 64, v11
  v_mul_u32_u24 v13, 6554, v12
  v_lshrrev_b32 v13, 16, v13
  v_mul_u32_u24 v14, 10, v13
  v_sub_u32 v12, v12, v14
  v_mul_u32_u24 v13, 1280, v13
  v_lshl_add_u32 v13, v12, 4, v13
  v_add_u32 v16, s30, v13
  v_add_u32 v12, 128, v11
  v_mul_u32_u24 v13, 6554, v12
  v_lshrrev_b32 v13, 16, v13
  v_mul_u32_u24 v14, 10, v13
  v_sub_u32 v12, v12, v14
  v_mul_u32_u24 v13, 1280, v13
  v_lshl_add_u32 v13, v12, 4, v13
  v_add_u32 v17, s30, v13
  v_add_u32 v12, 192, v11
  v_mul_u32_u24 v13, 6554, v12
  v_lshrrev_b32 v13, 16, v13
  v_mul_u32_u24 v14, 10, v13
  v_sub_u32 v12, v12, v14
  v_mul_u32_u24 v13, 1280, v13
  v_lshl_add_u32 v13, v12, 4, v13
  v_add_u32 v18, s30, v13
  v_add_u32 v12, 256, v11
  v_mul_u32_u24 v13, 6554, v12
  v_lshrrev_b32 v13, 16, v13
  v_mul_u32_u24 v14, 10, v13
  v_sub_u32 v12, v12, v14
  v_mul_u32_u24 v13, 1280, v13
  v_lshl_add_u32 v13, v12, 4, v13
  v_add_u32 v19, s30, v13
  s_mul_i32 s31, s28, 25600
  s_add_u32 s31, s31, 0
  s_mul_i32 s30, s28, 204800
  s_cmp_eq_u32 s91, 1
  s_cselect_b32 s14, 819200, 0
  s_mov_b32 s15, 0x20000
  s_waitcnt lgkmcnt(0)
  ds_read_b128 v[52:55], v6 offset:3584
  ds_read2_b32 v[88:89], v10 offset0:128 offset1:129
  ds_read2_b32 v[90:91], v10 offset0:130 offset1:131
  ds_read2_b32 v[92:93], v10 offset0:0 offset1:1
  ds_read2_b32 v[94:95], v10 offset0:2 offset1:3
  ds_read_b128 v[56:59], v6 offset:3072
  ds_read2_b32 v[96:97], v9 offset0:128 offset1:129
  ds_read2_b32 v[98:99], v9 offset0:130 offset1:131
  ds_read_b128 v[60:63], v6 offset:2560
  ds_read2_b32 v[100:101], v9 offset0:0 offset1:1
  ds_read2_b32 v[102:103], v9 offset0:2 offset1:3
  ds_read_b128 v[64:67], v6 offset:2048
  ds_read2_b32 v[104:105], v8 offset0:128 offset1:129
  ds_read2_b32 v[106:107], v8 offset0:130 offset1:131
  s_waitcnt lgkmcnt(11)
  v_mfma_f32_16x16x32_bf16 v[48:51], v[88:91], v[52:55], 0
  s_waitcnt lgkmcnt(9)
  v_mfma_f32_16x16x32_bf16 v[44:47], v[92:95], v[52:55], 0
  s_waitcnt lgkmcnt(8)
  v_mfma_f32_16x16x32_bf16 v[48:51], v[92:95], v[56:59], v[48:51]
  s_waitcnt lgkmcnt(6)
  v_mfma_f32_16x16x32_bf16 v[40:43], v[96:99], v[52:55], 0
  ds_read_b128 v[68:71], v6 offset:1536
  v_mfma_f32_16x16x32_bf16 v[44:47], v[96:99], v[56:59], v[44:47]
  s_cmp_lg_u32 s91, 1
  s_cbranch_scc1 L_wg_42
  s_add_u32 m0, s31, 0
  s_nop 0
  buffer_load_dwordx4 v15, s[12:15], s30 offen lds
L_wg_42:
  ds_read2_b32 v[88:89], v8 offset0:0 offset1:1
  ds_read2_b32 v[90:91], v8 offset0:2 offset1:3
  s_waitcnt lgkmcnt(8)
  v_mfma_f32_16x16x32_bf16 v[48:51], v[96:99], v[60:63], v[48:51]
  s_waitcnt lgkmcnt(6)
  v_mfma_f32_16x16x32_bf16 v[36:39], v[100:103], v[52:55], 0
  v_mfma_f32_16x16x32_bf16 v[40:43], v[100:103], v[56:59], v[40:43]
  v_mfma_f32_16x16x32_bf16 v[44:47], v[100:103], v[60:63], v[44:47]
  s_waitcnt lgkmcnt(5)
  v_mfma_f32_16x16x32_bf16 v[48:51], v[100:103], v[64:67], v[48:51]
  s_cmp_lg_u32 s91, 1
  s_cbranch_scc1 L_wg_43
  s_add_u32 m0, s31, 1024
  s_nop 0
  buffer_load_dwordx4 v16, s[12:15], s30 offen lds
L_wg_43:
  ds_read_b128 v[72:75], v6 offset:1024
  s_waitcnt lgkmcnt(4)
  v_mfma_f32_16x16x32_bf16 v[32:35], v[104:107], v[52:55], 0
  ds_read2_b32 v[92:93], v7 offset0:128 offset1:129
  ds_read2_b32 v[94:95], v7 offset0:130 offset1:131
  v_mfma_f32_16x16x32_bf16 v[36:39], v[104:107], v[56:59], v[36:39]
  v_mfma_f32_16x16x32_bf16 v[40:43], v[104:107], v[60:63], v[40:43]
  v_mfma_f32_16x16x32_bf16 v[44:47], v[104:107], v[64:67], v[44:47]
  s_waitcnt lgkmcnt(5)
  v_mfma_f32_16x16x32_bf16 v[48:51], v[104:107], v[68:71], v[48:51]
  s_cmp_lg_u32 s91, 1
  s_cbranch_scc1 L_wg_44
  s_add_u32 m0, s31, 2048
  s_nop 0
  buffer_load_dwordx4 v17, s[12:15], s30 offen lds
L_wg_44:
  s_waitcnt lgkmcnt(3)
  v_mfma_f32_16x16x32_bf16 v[28:31], v[88:91], v[52:55], 0
  v_mfma_f32_16x16x32_bf16 v[32:35], v[88:91], v[56:59], v[32:35]
  ds_read_b128 v[76:79], v6 offset:512
  v_mfma_f32_16x16x32_bf16 v[36:39], v[88:91], v[60:63], v[36:39]
  ds_read2_b32 v[96:97], v7 offset0:0 offset1:1
  ds_read2_b32 v[98:99], v7 offset0:2 offset1:3
  v_mfma_f32_16x16x32_bf16 v[40:43], v[88:91], v[64:67], v[40:43]
  v_mfma_f32_16x16x32_bf16 v[44:47], v[88:91], v[68:71], v[44:47]
  s_cmp_lg_u32 s91, 1
  s_cbranch_scc1 L_wg_45
  s_add_u32 m0, s31, 3072
  s_nop 0
  buffer_load_dwordx4 v18, s[12:15], s30 offen lds
L_wg_45:
  s_waitcnt lgkmcnt(5)
  v_mfma_f32_16x16x32_bf16 v[48:51], v[88:91], v[72:75], v[48:51]
  s_waitcnt lgkmcnt(3)
  v_mfma_f32_16x16x32_bf16 v[24:27], v[92:95], v[52:55], 0
  v_mfma_f32_16x16x32_bf16 v[28:31], v[92:95], v[56:59], v[28:31]
  v_mfma_f32_16x16x32_bf16 v[32:35], v[92:95], v[60:63], v[32:35]
  v_mfma_f32_16x16x32_bf16 v[36:39], v[92:95], v[64:67], v[36:39]
  s_cmp_lg_u32 s91, 1
  s_cbranch_scc1 L_wg_46
  s_add_u32 m0, s31, 4096
  s_nop 0
  buffer_load_dwordx4 v19, s[12:15], s30 offen lds
  s_add_u32 s30, s30, 40960
L_wg_46:
  ds_read_b128 v[80:83], v6 offset:0
  v_mfma_f32_16x16x32_bf16 v[40:43], v[92:95], v[68:71], v[40:43]
  ds_read_b128 v[84:87], v6 offset:3648
  ds_read2_b32 v[100:101], v7 offset0:16 offset1:17
  ds_read2_b32 v[102:103], v7 offset0:18 offset1:19
  v_mfma_f32_16x16x32_bf16 v[44:47], v[92:95], v[72:75], v[44:47]
  s_waitcnt lgkmcnt(6)
  v_mfma_f32_16x16x32_bf16 v[48:51], v[92:95], v[76:79], v[48:51]
  s_waitcnt lgkmcnt(4)
  v_mfma_f32_16x16x32_bf16 v[20:23], v[96:99], v[52:55], 0
  ds_read_b128 v[52:55], v6 offset:3136
  v_mfma_f32_16x16x32_bf16 v[24:27], v[96:99], v[56:59], v[24:27]
  s_cmp_lg_u32 s91, 1
  s_cbranch_scc1 L_wg_47
  s_add_u32 m0, s31, 5120
  s_nop 0
  buffer_load_dwordx4 v15, s[12:15], s30 offen lds
L_wg_47:
  ds_read_b128 v[56:59], v6 offset:2624
  v_mfma_f32_16x16x32_bf16 v[28:31], v[96:99], v[60:63], v[28:31]
  ds_read_b128 v[60:63], v6 offset:2112
  v_mfma_f32_16x16x32_bf16 v[32:35], v[96:99], v[64:67], v[32:35]
  ds_read_b128 v[64:67], v6 offset:1600
  v_mfma_f32_16x16x32_bf16 v[36:39], v[96:99], v[68:71], v[36:39]
  ds_read_b128 v[68:71], v6 offset:1088
  v_mfma_f32_16x16x32_bf16 v[40:43], v[96:99], v[72:75], v[40:43]
  ds_read_b128 v[72:75], v6 offset:576
  ds_read2_b32 v[104:105], v7 offset0:144 offset1:145
  ds_read2_b32 v[106:107], v7 offset0:146 offset1:147
  v_mfma_f32_16x16x32_bf16 v[44:47], v[96:99], v[76:79], v[44:47]
  s_cmp_lg_u32 s91, 1
  s_cbranch_scc1 L_wg_48
  s_add_u32 m0, s31, 6144
  s_nop 0
  buffer_load_dwordx4 v16, s[12:15], s30 offen lds
L_wg_48:
  ds_read_b128 v[76:79], v6 offset:64
  s_waitcnt lgkmcnt(12)
  v_mfma_f32_16x16x32_bf16 v[48:51], v[96:99], v[80:83], v[48:51]
  s_waitcnt lgkmcnt(9)
  v_mfma_f32_16x16x32_bf16 v[20:23], v[100:103], v[84:87], v[20:23]
  s_waitcnt lgkmcnt(8)
  v_mfma_f32_16x16x32_bf16 v[24:27], v[100:103], v[52:55], v[24:27]
  s_waitcnt lgkmcnt(7)
  v_mfma_f32_16x16x32_bf16 v[28:31], v[100:103], v[56:59], v[28:31]
  s_waitcnt lgkmcnt(6)
  v_mfma_f32_16x16x32_bf16 v[32:35], v[100:103], v[60:63], v[32:35]
  s_cmp_lg_u32 s91, 1
  s_cbranch_scc1 L_wg_49
  s_add_u32 m0, s31, 7168
  s_nop 0
  buffer_load_dwordx4 v17, s[12:15], s30 offen lds
L_wg_49:
  s_waitcnt lgkmcnt(5)
  v_mfma_f32_16x16x32_bf16 v[36:39], v[100:103], v[64:67], v[36:39]
  ds_read2_b32 v[88:89], v8 offset0:16 offset1:17
  ds_read2_b32 v[90:91], v8 offset0:18 offset1:19
  s_waitcnt lgkmcnt(6)
  v_mfma_f32_16x16x32_bf16 v[40:43], v[100:103], v[68:71], v[40:43]
  s_waitcnt lgkmcnt(5)
  v_mfma_f32_16x16x32_bf16 v[44:47], v[100:103], v[72:75], v[44:47]
  s_waitcnt lgkmcnt(2)
  v_mfma_f32_16x16x32_bf16 v[48:51], v[100:103], v[76:79], v[48:51]
  v_mfma_f32_16x16x32_bf16 v[24:27], v[104:107], v[84:87], v[24:27]
  s_cmp_lg_u32 s91, 1
  s_cbranch_scc1 L_wg_50
  s_add_u32 m0, s31, 8192
  s_nop 0
  buffer_load_dwordx4 v18, s[12:15], s30 offen lds
L_wg_50:
  v_mfma_f32_16x16x32_bf16 v[28:31], v[104:107], v[52:55], v[28:31]
  v_mfma_f32_16x16x32_bf16 v[32:35], v[104:107], v[56:59], v[32:35]
  ds_read2_b32 v[92:93], v8 offset0:144 offset1:145
  ds_read2_b32 v[94:95], v8 offset0:146 offset1:147
  v_mfma_f32_16x16x32_bf16 v[36:39], v[104:107], v[60:63], v[36:39]
  v_mfma_f32_16x16x32_bf16 v[40:43], v[104:107], v[64:67], v[40:43]
  v_mfma_f32_16x16x32_bf16 v[44:47], v[104:107], v[68:71], v[44:47]
  s_cmp_lg_u32 s91, 1
  s_cbranch_scc1 L_wg_51
  s_add_u32 m0, s31, 9216
  s_nop 0
  buffer_load_dwordx4 v19, s[12:15], s30 offen lds
  s_add_u32 s30, s30, 40960
L_wg_51:
  v_mfma_f32_16x16x32_bf16 v[48:51], v[104:107], v[72:75], v[48:51]
  s_waitcnt lgkmcnt(2)
  v_mfma_f32_16x16x32_bf16 v[28:31], v[88:91], v[84:87], v[28:31]
  ds_read2_b32 v[96:97], v9 offset0:16 offset1:17
  ds_read2_b32 v[98:99], v9 offset0:18 offset1:19
  v_mfma_f32_16x16x32_bf16 v[32:35], v[88:91], v[52:55], v[32:35]
  v_mfma_f32_16x16x32_bf16 v[36:39], v[88:91], v[56:59], v[36:39]
  v_mfma_f32_16x16x32_bf16 v[40:43], v[88:91], v[60:63], v[40:43]
  s_cmp_lg_u32 s91, 1
  s_cbranch_scc1 L_wg_52
  s_add_u32 m0, s31, 10240
  s_nop 0
  buffer_load_dwordx4 v15, s[12:15], s30 offen lds
L_wg_52:
  v_mfma_f32_16x16x32_bf16 v[44:47], v[88:91], v[64:67], v[44:47]
  ds_read2_b32 v[100:101], v9 offset0:144 offset1:145
  ds_read2_b32 v[102:103], v9 offset0:146 offset1:147
  v_mfma_f32_16x16x32_bf16 v[48:51], v[88:91], v[68:71], v[48:51]
  s_waitcnt lgkmcnt(4)
  v_mfma_f32_16x16x32_bf16 v[32:35], v[92:95], v[84:87], v[32:35]
  v_mfma_f32_16x16x32_bf16 v[36:39], v[92:95], v[52:55], v[36:39]
  ds_read2_b32 v[104:105], v10 offset0:16 offset1:17
  ds_read2_b32 v[106:107], v10 offset0:18 offset1:19
  v_mfma_f32_16x16x32_bf16 v[40:43], v[92:95], v[56:59], v[40:43]
  s_cmp_lg_u32 s91, 1
  s_cbranch_scc1 L_wg_53
  s_add_u32 m0, s31, 11264
  s_nop 0
  buffer_load_dwordx4 v16, s[12:15], s30 offen lds
L_wg_53:
  v_mfma_f32_16x16x32_bf16 v[44:47], v[92:95], v[60:63], v[44:47]
  ds_read2_b32 v[88:89], v10 offset0:144 offset1:145
  ds_read2_b32 v[90:91], v10 offset0:146 offset1:147
  v_mfma_f32_16x16x32_bf16 v[48:51], v[92:95], v[64:67], v[48:51]
  ds_read_b128 v[80:83], v6 offset:3712
  ds_read2_b32 v[92:93], v10 offset0:160 offset1:161
  ds_read2_b32 v[94:95], v10 offset0:162 offset1:163
  s_waitcnt lgkmcnt(9)
  v_mfma_f32_16x16x32_bf16 v[36:39], v[96:99], v[84:87], v[36:39]
  v_mfma_f32_16x16x32_bf16 v[40:43], v[96:99], v[52:55], v[40:43]
  ds_read_b128 v[76:79], v6 offset:3200
  v_mfma_f32_16x16x32_bf16 v[44:47], v[96:99], v[56:59], v[44:47]
  s_cmp_lg_u32 s91, 1
  s_cbranch_scc1 L_wg_54
  s_add_u32 m0, s31, 12288
  s_nop 0
  buffer_load_dwordx4 v17, s[12:15], s30 offen lds
L_wg_54:
  v_mfma_f32_16x16x32_bf16 v[48:51], v[96:99], v[60:63], v[48:51]
  ds_read2_b32 v[96:97], v10 offset0:32 offset1:33
  ds_read2_b32 v[98:99], v10 offset0:34 offset1:35
  s_waitcnt lgkmcnt(10)
  v_mfma_f32_16x16x32_bf16 v[40:43], v[100:103], v[84:87], v[40:43]
  ds_read_b128 v[72:75], v6 offset:2688
  v_mfma_f32_16x16x32_bf16 v[44:47], v[100:103], v[52:55], v[44:47]
  v_mfma_f32_16x16x32_bf16 v[48:51], v[100:103], v[56:59], v[48:51]
  ds_read2_b32 v[100:101], v9 offset0:160 offset1:161
  ds_read2_b32 v[102:103], v9 offset0:162 offset1:163
  s_waitcnt lgkmcnt(11)
  v_mfma_f32_16x16x32_bf16 v[44:47], v[104:107], v[84:87], v[44:47]
  s_cmp_lg_u32 s91, 1
  s_cbranch_scc1 L_wg_55
  s_add_u32 m0, s31, 13312
  s_nop 0
  buffer_load_dwordx4 v18, s[12:15], s30 offen lds
L_wg_55:
  v_mfma_f32_16x16x32_bf16 v[48:51], v[104:107], v[52:55], v[48:51]
  ds_read2_b32 v[104:105], v9 offset0:32 offset1:33
  ds_read2_b32 v[106:107], v9 offset0:34 offset1:35
  ds_read_b128 v[68:71], v6 offset:2176
  s_waitcnt lgkmcnt(12)
  v_mfma_f32_16x16x32_bf16 v[48:51], v[88:91], v[84:87], v[48:51]
  ds_read2_b32 v[88:89], v8 offset0:160 offset1:161
  ds_read2_b32 v[90:91], v8 offset0:162 offset1:163
  s_waitcnt lgkmcnt(11)
  v_mfma_f32_16x16x32_bf16 v[48:51], v[92:95], v[80:83], v[48:51]
  s_waitcnt lgkmcnt(8)
  v_mfma_f32_16x16x32_bf16 v[44:47], v[96:99], v[80:83], v[44:47]
  v_mfma_f32_16x16x32_bf16 v[48:51], v[96:99], v[76:79], v[48:51]
  s_cmp_lg_u32 s91, 1
  s_cbranch_scc1 L_wg_56
  s_add_u32 m0, s31, 14336
  s_nop 0
  buffer_load_dwordx4 v19, s[12:15], s30 offen lds
  s_add_u32 s30, s30, 40960
L_wg_56:
  s_waitcnt lgkmcnt(5)
  v_mfma_f32_16x16x32_bf16 v[40:43], v[100:103], v[80:83], v[40:43]
  ds_read_b128 v[64:67], v6 offset:1664
  v_mfma_f32_16x16x32_bf16 v[44:47], v[100:103], v[76:79], v[44:47]
  ds_read2_b32 v[92:93], v8 offset0:32 offset1:33
  ds_read2_b32 v[94:95], v8 offset0:34 offset1:35
  v_mfma_f32_16x16x32_bf16 v[48:51], v[100:103], v[72:75], v[48:51]
  s_waitcnt lgkmcnt(6)
  v_mfma_f32_16x16x32_bf16 v[36:39], v[104:107], v[80:83], v[36:39]
  v_mfma_f32_16x16x32_bf16 v[40:43], v[104:107], v[76:79], v[40:43]
  s_cmp_lg_u32 s91, 1
  s_cbranch_scc1 L_wg_57
  s_add_u32 m0, s31, 15360
  s_nop 0
  buffer_load_dwordx4 v15, s[12:15], s30 offen lds
L_wg_57:
  v_mfma_f32_16x16x32_bf16 v[44:47], v[104:107], v[72:75], v[44:47]
  s_waitcnt lgkmcnt(5)
  v_mfma_f32_16x16x32_bf16 v[48:51], v[104:107], v[68:71], v[48:51]
  ds_read_b128 v[60:63], v6 offset:1152
  s_waitcnt lgkmcnt(4)
  v_mfma_f32_16x16x32_bf16 v[32:35], v[88:91], v[80:83], v[32:35]
  ds_read2_b32 v[96:97], v7 offset0:160 offset1:161
  ds_read2_b32 v[98:99], v7 offset0:162 offset1:163
  v_mfma_f32_16x16x32_bf16 v[36:39], v[88:91], v[76:79], v[36:39]
  v_mfma_f32_16x16x32_bf16 v[40:43], v[88:91], v[72:75], v[40:43]
  s_cmp_lg_u32 s91, 1
  s_cbranch_scc1 L_wg_58
  s_add_u32 m0, s31, 16384
  s_nop 0
  buffer_load_dwordx4 v16, s[12:15], s30 offen lds
L_wg_58:
  v_mfma_f32_16x16x32_bf16 v[44:47], v[88:91], v[68:71], v[44:47]
  s_waitcnt lgkmcnt(5)
  v_mfma_f32_16x16x32_bf16 v[48:51], v[88:91], v[64:67], v[48:51]
  s_waitcnt lgkmcnt(3)
  v_mfma_f32_16x16x32_bf16 v[28:31], v[92:95], v[80:83], v[28:31]
  v_mfma_f32_16x16x32_bf16 v[32:35], v[92:95], v[76:79], v[32:35]
  ds_read_b128 v[56:59], v6 offset:640
  v_mfma_f32_16x16x32_bf16 v[36:39], v[92:95], v[72:75], v[36:39]
  s_cmp_lg_u32 s91, 1
  s_cbranch_scc1 L_wg_59
  s_add_u32 m0, s31, 17408
  s_nop 0
  buffer_load_dwordx4 v17, s[12:15], s30 offen lds
L_wg_59:
  ds_read2_b32 v[100:101], v7 offset0:32 offset1:33
  ds_read2_b32 v[102:103], v7 offset0:34 offset1:35
  v_mfma_f32_16x16x32_bf16 v[40:43], v[92:95], v[68:71], v[40:43]
  v_mfma_f32_16x16x32_bf16 v[44:47], v[92:95], v[64:67], v[44:47]
  s_waitcnt lgkmcnt(5)
  v_mfma_f32_16x16x32_bf16 v[48:51], v[92:95], v[60:63], v[48:51]
  s_waitcnt lgkmcnt(3)
  v_mfma_f32_16x16x32_bf16 v[24:27], v[96:99], v[80:83], v[24:27]
  v_mfma_f32_16x16x32_bf16 v[28:31], v[96:99], v[76:79], v[28:31]
  s_cmp_lg_u32 s91, 1
  s_cbranch_scc1 L_wg_60
  s_add_u32 m0, s31, 18432
  s_nop 0
  buffer_load_dwordx4 v18, s[12:15], s30 offen lds
L_wg_60:
  v_mfma_f32_16x16x32_bf16 v[32:35], v[96:99], v[72:75], v[32:35]
  v_mfma_f32_16x16x32_bf16 v[36:39], v[96:99], v[68:71], v[36:39]
  ds_read_b128 v[52:55], v6 offset:128
  v_mfma_f32_16x16x32_bf16 v[40:43], v[96:99], v[64:67], v[40:43]
  ds_read_b128 v[84:87], v6 offset:3776
  ds_read2_b32 v[104:105], v7 offset0:48 offset1:49
  ds_read2_b32 v[106:107], v7 offset0:50 offset1:51
  v_mfma_f32_16x16x32_bf16 v[44:47], v[96:99], v[60:63], v[44:47]
  s_waitcnt lgkmcnt(6)
  v_mfma_f32_16x16x32_bf16 v[48:51], v[96:99], v[56:59], v[48:51]
  s_cmp_lg_u32 s91, 1
  s_cbranch_scc1 L_wg_61
  s_add_u32 m0, s31, 19456
  s_nop 0
  buffer_load_dwordx4 v19, s[12:15], s30 offen lds
  s_add_u32 s30, s30, 40960
L_wg_61:
  s_waitcnt lgkmcnt(4)
  v_mfma_f32_16x16x32_bf16 v[20:23], v[100:103], v[80:83], v[20:23]
  ds_read_b128 v[80:83], v6 offset:3264
  v_mfma_f32_16x16x32_bf16 v[24:27], v[100:103], v[76:79], v[24:27]
  ds_read_b128 v[76:79], v6 offset:2752
  v_mfma_f32_16x16x32_bf16 v[28:31], v[100:103], v[72:75], v[28:31]
  ds_read_b128 v[72:75], v6 offset:2240
  v_mfma_f32_16x16x32_bf16 v[32:35], v[100:103], v[68:71], v[32:35]
  ds_read_b128 v[68:71], v6 offset:1728
  v_mfma_f32_16x16x32_bf16 v[36:39], v[100:103], v[64:67], v[36:39]
  s_cmp_lg_u32 s91, 1
  s_cbranch_scc1 L_wg_62
  s_add_u32 m0, s31, 20480
  s_nop 0
  buffer_load_dwordx4 v15, s[12:15], s30 offen lds
L_wg_62:
  ds_read_b128 v[64:67], v6 offset:1216
  v_mfma_f32_16x16x32_bf16 v[40:43], v[100:103], v[60:63], v[40:43]
  ds_read_b128 v[60:63], v6 offset:704
  ds_read2_b32 v[88:89], v7 offset0:176 offset1:177
  ds_read2_b32 v[90:91], v7 offset0:178 offset1:179
  v_mfma_f32_16x16x32_bf16 v[44:47], v[100:103], v[56:59], v[44:47]
  ds_read_b128 v[56:59], v6 offset:192
  s_waitcnt lgkmcnt(12)
  v_mfma_f32_16x16x32_bf16 v[48:51], v[100:103], v[52:55], v[48:51]
  s_waitcnt lgkmcnt(9)
  v_mfma_f32_16x16x32_bf16 v[20:23], v[104:107], v[84:87], v[20:23]
  s_waitcnt lgkmcnt(8)
  v_mfma_f32_16x16x32_bf16 v[24:27], v[104:107], v[80:83], v[24:27]
  s_cmp_lg_u32 s91, 1
  s_cbranch_scc1 L_wg_63
  s_add_u32 m0, s31, 21504
  s_nop 0
  buffer_load_dwordx4 v16, s[12:15], s30 offen lds
L_wg_63:
  s_waitcnt lgkmcnt(7)
  v_mfma_f32_16x16x32_bf16 v[28:31], v[104:107], v[76:79], v[28:31]
  s_waitcnt lgkmcnt(6)
  v_mfma_f32_16x16x32_bf16 v[32:35], v[104:107], v[72:75], v[32:35]
  s_waitcnt lgkmcnt(5)
  v_mfma_f32_16x16x32_bf16 v[36:39], v[104:107], v[68:71], v[36:39]
  ds_read2_b32 v[92:93], v8 offset0:48 offset1:49
  ds_read2_b32 v[94:95], v8 offset0:50 offset1:51
  s_waitcnt lgkmcnt(6)
  v_mfma_f32_16x16x32_bf16 v[40:43], v[104:107], v[64:67], v[40:43]
  s_waitcnt lgkmcnt(5)
  v_mfma_f32_16x16x32_bf16 v[44:47], v[104:107], v[60:63], v[44:47]
  s_cmp_lg_u32 s91, 1
  s_cbranch_scc1 L_wg_64
  s_add_u32 m0, s31, 22528
  s_nop 0
  buffer_load_dwordx4 v17, s[12:15], s30 offen lds
L_wg_64:
  s_waitcnt lgkmcnt(2)
  v_mfma_f32_16x16x32_bf16 v[48:51], v[104:107], v[56:59], v[48:51]
  v_mfma_f32_16x16x32_bf16 v[24:27], v[88:91], v[84:87], v[24:27]
  v_mfma_f32_16x16x32_bf16 v[28:31], v[88:91], v[80:83], v[28:31]
  v_mfma_f32_16x16x32_bf16 v[32:35], v[88:91], v[76:79], v[32:35]
  ds_read2_b32 v[96:97], v8 offset0:176 offset1:177
  ds_read2_b32 v[98:99], v8 offset0:178 offset1:179
  v_mfma_f32_16x16x32_bf16 v[36:39], v[88:91], v[72:75], v[36:39]
  s_cmp_lg_u32 s91, 1
  s_cbranch_scc1 L_wg_65
  s_add_u32 m0, s31, 23552
  s_nop 0
  buffer_load_dwordx4 v18, s[12:15], s30 offen lds
L_wg_65:
  v_mfma_f32_16x16x32_bf16 v[40:43], v[88:91], v[68:71], v[40:43]
  v_mfma_f32_16x16x32_bf16 v[44:47], v[88:91], v[64:67], v[44:47]
  v_mfma_f32_16x16x32_bf16 v[48:51], v[88:91], v[60:63], v[48:51]
  s_waitcnt lgkmcnt(2)
  v_mfma_f32_16x16x32_bf16 v[28:31], v[92:95], v[84:87], v[28:31]
  ds_read2_b32 v[100:101], v9 offset0:48 offset1:49
  ds_read2_b32 v[102:103], v9 offset0:50 offset1:51
  v_mfma_f32_16x16x32_bf16 v[32:35], v[92:95], v[80:83], v[32:35]
  s_cmp_lg_u32 s91, 1
  s_cbranch_scc1 L_wg_66
  s_add_u32 m0, s31, 24576
  s_nop 0
  buffer_load_dwordx4 v19, s[12:15], s30 offen lds
  s_add_u32 s30, s30, 40960
L_wg_66:
  v_mfma_f32_16x16x32_bf16 v[36:39], v[92:95], v[76:79], v[36:39]
  v_mfma_f32_16x16x32_bf16 v[40:43], v[92:95], v[72:75], v[40:43]
  v_mfma_f32_16x16x32_bf16 v[44:47], v[92:95], v[68:71], v[44:47]
  ds_read2_b32 v[104:105], v9 offset0:176 offset1:177
  ds_read2_b32 v[106:107], v9 offset0:178 offset1:179
  v_mfma_f32_16x16x32_bf16 v[48:51], v[92:95], v[64:67], v[48:51]
  s_waitcnt lgkmcnt(4)
  v_mfma_f32_16x16x32_bf16 v[32:35], v[96:99], v[84:87], v[32:35]
  v_mfma_f32_16x16x32_bf16 v[36:39], v[96:99], v[80:83], v[36:39]
  ds_read2_b32 v[88:89], v10 offset0:48 offset1:49
  ds_read2_b32 v[90:91], v10 offset0:50 offset1:51
  v_mfma_f32_16x16x32_bf16 v[40:43], v[96:99], v[76:79], v[40:43]
  v_mfma_f32_16x16x32_bf16 v[44:47], v[96:99], v[72:75], v[44:47]
  ds_read2_b32 v[92:93], v10 offset0:176 offset1:177
  ds_read2_b32 v[94:95], v10 offset0:178 offset1:179
  v_mfma_f32_16x16x32_bf16 v[48:51], v[96:99], v[68:71], v[48:51]
  s_waitcnt lgkmcnt(6)
  v_mfma_f32_16x16x32_bf16 v[36:39], v[100:103], v[84:87], v[36:39]
  v_mfma_f32_16x16x32_bf16 v[40:43], v[100:103], v[80:83], v[40:43]
  v_mfma_f32_16x16x32_bf16 v[44:47], v[100:103], v[76:79], v[44:47]
  v_mfma_f32_16x16x32_bf16 v[48:51], v[100:103], v[72:75], v[48:51]
  s_waitcnt lgkmcnt(4)
  v_mfma_f32_16x16x32_bf16 v[40:43], v[104:107], v[84:87], v[40:43]
  v_mfma_f32_16x16x32_bf16 v[44:47], v[104:107], v[80:83], v[44:47]
  v_mfma_f32_16x16x32_bf16 v[48:51], v[104:107], v[76:79], v[48:51]
  s_waitcnt lgkmcnt(2)
  v_mfma_f32_16x16x32_bf16 v[44:47], v[88:91], v[84:87], v[44:47]
  v_mfma_f32_16x16x32_bf16 v[48:51], v[88:91], v[80:83], v[48:51]
  s_waitcnt lgkmcnt(0)
  v_mfma_f32_16x16x32_bf16 v[48:51], v[92:95], v[84:87], v[48:51]
  v_mbcnt_lo_u32_b32 v245, -1, 0
  v_mbcnt_hi_u32_b32 v245, -1, v245
  v_lshlrev_b32 v244, 2, v245
  v_add_u32 v244, 8130560, v244
  s_and_b32 s29, s2, 7
  s_lshl_b32 s29, s29, 1
  s_lshr_b32 s30, s2, 7
  s_add_u32 s29, s29, s30
  s_lshl_b32 s29, s29, 4
  s_add_u32 s29, s29, 8131072
  v_and_b32 v245, 3, v245
  v_lshl_add_u32 v245, v245, 2, s29
  s_cmp_lg_u32 s28, 0
  s_cbranch_scc1 L_kqi_67
  s_cmp_lg_u32 s91, 1
  s_cbranch_scc1 L_kqi_67
  global_load_dword v246, v244, s[50:51] sc1
  global_load_dword v247, v244, s[50:51] offset:256 sc1
  global_load_dword v248, v245, s[50:51] sc1
L_kqi_67:
  s_lshl_b32 s100, s28, 12
  v_lshl_add_u32 v108, v1, 4, s100
  v_xor_b32 v109, 4096, v108
  s_add_u32 s100, s85, 33920
  v_add_u32 v108, s100, v108
  v_add_u32 v109, s100, v109
  v_lshlrev_b32 v2, 5, v4
  v_lshl_add_u32 v2, v5, 3, v2
  s_lshl_b32 s100, s98, 11
  s_add_u32 s101, s100, s96
  v_add_u32 v3, s101, v2
  s_lshl_b32 s101, s99, 12
  s_add_u32 s101, s101, s100
  v_add_u32 v2, s101, v2
  ds_read_b64 v[88:89], v3 offset:32
  ds_read_b64 v[92:93], v3 offset:544
  ds_read_b64 v[96:97], v3 offset:1056
  ds_read_b64 v[100:101], v3 offset:1568
  s_cmp_eq_u32 s98, 1
  s_cbranch_scc1 L_c_e1_68
  ds_write_b128 v108, v[36:39] offset:0
  ds_write_b128 v108, v[40:43] offset:1024
  ds_write_b128 v108, v[44:47] offset:2048
  ds_write_b128 v108, v[48:51] offset:3072
  s_branch L_c_ej_69
L_c_e1_68:
  ds_write_b128 v108, v[20:23] offset:0
  ds_write_b128 v108, v[24:27] offset:1024
  ds_write_b128 v108, v[28:31] offset:2048
  ds_write_b128 v108, v[32:35] offset:3072
  s_waitcnt lgkmcnt(0)
  v_pk_mov_b32 v[20:21], v[36:37], v[36:37] op_sel:[0,1]
  v_pk_mov_b32 v[22:23], v[38:39], v[38:39] op_sel:[0,1]
  v_pk_mov_b32 v[24:25], v[40:41], v[40:41] op_sel:[0,1]
  v_pk_mov_b32 v[26:27], v[42:43], v[42:43] op_sel:[0,1]
  v_pk_mov_b32 v[28:29], v[44:45], v[44:45] op_sel:[0,1]
  v_pk_mov_b32 v[30:31], v[46:47], v[46:47] op_sel:[0,1]
  v_pk_mov_b32 v[32:33], v[48:49], v[48:49] op_sel:[0,1]
  v_pk_mov_b32 v[34:35], v[50:51], v[50:51] op_sel:[0,1]
L_c_ej_69:
  s_waitcnt lgkmcnt(0)
  s_barrier
  ds_read_b128 v[52:55], v109 offset:0
  ds_read_b128 v[56:59], v109 offset:1024
  ds_read_b128 v[60:63], v109 offset:2048
  ds_read_b128 v[64:67], v109 offset:3072
  v_mov_b32 v110, v239
  v_mov_b32 v111, v239
  v_lshlrev_b32 v68, 16, v88
  v_and_b32 v69, 0xffff0000, v88
  v_lshlrev_b32 v70, 16, v89
  v_and_b32 v71, 0xffff0000, v89
  v_pk_fma_f32 v[68:69], v[68:69], v[110:111], v[20:21]
  v_pk_fma_f32 v[70:71], v[70:71], v[110:111], v[22:23]
  s_waitcnt lgkmcnt(3)
  v_pk_add_f32 v[52:53], v[52:53], v[68:69]
  v_pk_add_f32 v[54:55], v[54:55], v[70:71]
  v_cvt_pk_bf16_f32 v88, v52, v53
  v_cvt_pk_bf16_f32 v89, v54, v55
  global_store_dwordx2 v2, v[88:89], s[50:51] offset:0 sc0 sc1
  v_lshlrev_b32 v72, 16, v92
  v_and_b32 v73, 0xffff0000, v92
  v_lshlrev_b32 v74, 16, v93
  v_and_b32 v75, 0xffff0000, v93
  v_pk_fma_f32 v[72:73], v[72:73], v[110:111], v[24:25]
  v_pk_fma_f32 v[74:75], v[74:75], v[110:111], v[26:27]
  s_waitcnt lgkmcnt(2)
  v_pk_add_f32 v[56:57], v[56:57], v[72:73]
  v_pk_add_f32 v[58:59], v[58:59], v[74:75]
  v_cvt_pk_bf16_f32 v92, v56, v57
  v_cvt_pk_bf16_f32 v93, v58, v59
  global_store_dwordx2 v2, v[92:93], s[50:51] offset:512 sc0 sc1
  v_lshlrev_b32 v68, 16, v96
  v_and_b32 v69, 0xffff0000, v96
  v_lshlrev_b32 v70, 16, v97
  v_and_b32 v71, 0xffff0000, v97
  v_pk_fma_f32 v[68:69], v[68:69], v[110:111], v[28:29]
  v_pk_fma_f32 v[70:71], v[70:71], v[110:111], v[30:31]
  s_waitcnt lgkmcnt(1)
  v_pk_add_f32 v[60:61], v[60:61], v[68:69]
  v_pk_add_f32 v[62:63], v[62:63], v[70:71]
  v_cvt_pk_bf16_f32 v96, v60, v61
  v_cvt_pk_bf16_f32 v97, v62, v63
  global_store_dwordx2 v2, v[96:97], s[50:51] offset:1024 sc0 sc1
  v_lshlrev_b32 v72, 16, v100
  v_and_b32 v73, 0xffff0000, v100
  v_lshlrev_b32 v74, 16, v101
  v_and_b32 v75, 0xffff0000, v101
  v_pk_fma_f32 v[72:73], v[72:73], v[110:111], v[32:33]
  v_pk_fma_f32 v[74:75], v[74:75], v[110:111], v[34:35]
  s_waitcnt lgkmcnt(0)
  v_pk_add_f32 v[64:65], v[64:65], v[72:73]
  v_pk_add_f32 v[66:67], v[66:67], v[74:75]
  v_cvt_pk_bf16_f32 v100, v64, v65
  v_cvt_pk_bf16_f32 v101, v66, v67
  global_store_dwordx2 v2, v[100:101], s[50:51] offset:1536 sc0 sc1
  s_lshl_b32 s88, s90, 2
  s_add_u32 s88, s88, 8131584
  s_add_u32 s90, s90, 1
  s_sub_u32 s91, s91, 1
  s_cmp_eq_u32 s91, 0
  s_cbranch_scc1 L_final
  v_mov_b32 v239, v223
  s_mov_b32 s85, 113536
  s_lshr_b32 s97, s28, 1
  s_and_b32 s98, s28, 1
  s_lshl_b32 s99, s90, 1
  s_add_u32 s99, s99, s97
  s_mul_i32 s95, s28, 4608
  s_add_u32 s95, s95, 17344
  s_add_u32 s95, s95, s85
  s_mul_i32 s94, s97, 4576
  s_add_u32 s94, s94, s85
  s_mul_i32 s96, s97, 8288
  s_add_u32 s96, s96, 17344
  s_add_u32 s96, s96, s85
  s_branch L_fc
L_final:
  v_mbcnt_lo_u32_b32 v0, -1, 0
  v_mbcnt_hi_u32_b32 v0, -1, v0
  s_lshl_b32 s29, s28, 6
  v_add_u32 v0, s29, v0
  s_and_b32 s5, s2, 7
  s_lshr_b32 s6, s2, 3
  s_lshr_b32 s3, s6, 3
  s_lshl_b32 s5, s5, 2
  s_add_u32 s3, s3, s5
  s_and_b32 s4, s6, 7
  s_load_dwordx2 s[16:17], s[0:1], 104
  v_and_b32 v1, 63, v0
  v_lshlrev_b32 v7, 4, v1
  s_mul_i32 s35, s28, 25600
  s_add_u32 s35, s35, 0
  s_mul_i32 s29, s3, 98304
  s_mul_i32 s30, s28, 6144
  s_add_u32 s29, s29, s30
  s_add_u32 s29, s29, 8388608
  s_add_u32 s20, s50, s29
  s_addc_u32 s21, s51, 0
  s_mov_b32 s22, 98304
  s_mov_b32 s23, 0x20000
  s_add_u32 s29, s28, 1
  s_and_b32 s29, s29, 3
  s_mul_i32 s40, s29, 24576
  s_add_u32 s24, s40, 3072
  s_add_u32 s29, s28, 2
  s_and_b32 s29, s29, 3
  s_mul_i32 s41, s29, 24576
  s_add_u32 s25, s41, 3072
  s_add_u32 s29, s28, 3
  s_and_b32 s29, s29, 3
  s_mul_i32 s42, s29, 24576
  s_add_u32 s26, s42, 3072
  s_add_u32 s29, s28, 4
  s_and_b32 s29, s29, 3
  s_mul_i32 s43, s29, 24576
  s_add_u32 s27, s43, 3072
  s_mul_i32 s29, s28, 13440
  s_add_u32 s29, s29, 7995392
  s_add_u32 s44, s50, s29
  s_addc_u32 s45, s51, 0
  s_mov_b32 s46, 13440
  s_mov_b32 s47, 0x20000
  s_mov_b32 s62, -1
  s_mov_b32 s63, 0xffff
  s_mov_b32 exec_lo, 0
  s_mov_b32 exec_hi, 0xffff0000
  v_mov_b64 v[12:13], 0
  v_mov_b64 v[14:15], 0
  v_mov_b64 v[16:17], 0
  v_mov_b64 v[18:19], 0
  v_mov_b64 v[20:21], 0
  v_mov_b64 v[22:23], 0
  v_mov_b64 v[24:25], 0
  v_mov_b64 v[26:27], 0
  v_mov_b64 v[28:29], 0
  v_mov_b64 v[30:31], 0
  v_mov_b64 v[32:33], 0
  v_mov_b64 v[34:35], 0
  v_mov_b64 v[36:37], 0
  v_mov_b64 v[38:39], 0
  v_mov_b64 v[40:41], 0
  v_mov_b64 v[42:43], 0
  v_mov_b64 v[44:45], 0
  v_mov_b64 v[46:47], 0
  v_mov_b64 v[48:49], 0
  v_mov_b64 v[50:51], 0
  v_mov_b64 v[52:53], 0
  v_mov_b64 v[54:55], 0
  v_mov_b64 v[56:57], 0
  v_mov_b64 v[58:59], 0
  v_mov_b64 v[60:61], 0
  v_mov_b64 v[62:63], 0
  v_mov_b64 v[64:65], 0
  v_mov_b64 v[66:67], 0
  v_mov_b64 v[68:69], 0
  v_mov_b64 v[70:71], 0
  v_mov_b64 v[72:73], 0
  v_mov_b64 v[74:75], 0
  s_mov_b64 exec, -1
  s_waitcnt vmcnt(4)
  s_cmp_lg_u32 s28, 0
  s_cbranch_scc1 L_cko_71
L_ck_70:
  v_cmp_ne_u32 vcc, s52, v246
  v_cmp_ne_u32 s[30:31], s52, v247
  s_nop 0
  s_or_b64 vcc, vcc, s[30:31]
  v_cmp_ne_u32 s[30:31], s52, v248
  s_nop 0
  s_or_b64 vcc, vcc, s[30:31]
  s_cmp_eq_u64 vcc, 0
  s_cbranch_scc1 L_cko_71
  s_sleep 2
  s_add_u32 s93, s93, 1
  s_cmp_gt_u32 s93, 300000
  s_cbranch_scc1 L_cko_71
  global_load_dword v246, v244, s[50:51] sc1
  global_load_dword v247, v244, s[50:51] offset:256 sc1
  global_load_dword v248, v245, s[50:51] sc1
  s_waitcnt vmcnt(0)
  s_branch L_ck_70
L_cko_71:
  s_barrier
  s_mov_b32 s29, 0
  buffer_load_dwordx4 v[76:79], v7, s[44:47], s29 offen offset:0
  buffer_load_dwordx4 v[80:83], v7, s[44:47], s29 offen offset:1024
  buffer_load_dwordx4 v[84:87], v7, s[44:47], s29 offen offset:2048
  buffer_load_dwordx4 v[88:91], v7, s[44:47], s29 offen offset:3072
  s_mov_b32 s29, 4096
  buffer_load_dwordx4 v[92:95], v7, s[44:47], s29 offen offset:0
  buffer_load_dwordx4 v[96:99], v7, s[44:47], s29 offen offset:1024
  buffer_load_dwordx4 v[100:103], v7, s[44:47], s29 offen offset:2048
  buffer_load_dwordx4 v[104:107], v7, s[44:47], s29 offen offset:3072
  s_mov_b32 s29, 8192
  buffer_load_dwordx4 v[108:111], v7, s[44:47], s29 offen offset:0
  buffer_load_dwordx4 v[112:115], v7, s[44:47], s29 offen offset:1024
  buffer_load_dwordx4 v[116:119], v7, s[44:47], s29 offen offset:2048
  buffer_load_dwordx4 v[120:123], v7, s[44:47], s29 offen offset:3072
  s_mov_b32 s29, 12288
  buffer_load_dwordx4 v[124:127], v7, s[44:47], s29 offen offset:0
  buffer_load_dwordx4 v[128:131], v7, s[44:47], s29 offen offset:1024
  s_mov_b64 exec, s[62:63]
  buffer_load_dwordx4 v[12:15], v7, s[20:23], s40 offen offset:0
  buffer_load_dwordx4 v[16:19], v7, s[20:23], s40 offen offset:768
  buffer_load_dwordx4 v[20:23], v7, s[20:23], s40 offen offset:1536
  buffer_load_dwordx4 v[24:27], v7, s[20:23], s40 offen offset:2304
  buffer_load_dwordx4 v[28:31], v7, s[20:23], s24 offen offset:0
  buffer_load_dwordx4 v[32:35], v7, s[20:23], s24 offen offset:768
  buffer_load_dwordx4 v[36:39], v7, s[20:23], s24 offen offset:1536
  buffer_load_dwordx4 v[40:43], v7, s[20:23], s24 offen offset:2304
  buffer_load_dwordx4 v[44:47], v7, s[20:23], s41 offen offset:0
  buffer_load_dwordx4 v[48:51], v7, s[20:23], s41 offen offset:768
  buffer_load_dwordx4 v[52:55], v7, s[20:23], s41 offen offset:1536
  buffer_load_dwordx4 v[56:59], v7, s[20:23], s41 offen offset:2304
  buffer_load_dwordx4 v[60:63], v7, s[20:23], s25 offen offset:0
  buffer_load_dwordx4 v[64:67], v7, s[20:23], s25 offen offset:768
  buffer_load_dwordx4 v[68:71], v7, s[20:23], s25 offen offset:1536
  buffer_load_dwordx4 v[72:75], v7, s[20:23], s25 offen offset:2304
  s_mov_b64 exec, -1
  v_and_b32 v2, 15, v1
  v_lshrrev_b32 v3, 4, v1
  v_lshrrev_b32 v10, 2, v2
  v_and_b32 v11, 3, v2
  v_lshl_add_u32 v11, v11, 3, s35
  v_lshlrev_b32 v6, 3, v10
  s_mov_b32 s29, 218890496
  s_mov_b32 s30, 33686275
  v_bfe_u32 v4, s29, v6, 8
  v_bfe_u32 v5, s30, v6, 8
  v_mad_u32_u24 v4, v5, v3, v4
  v_mul_u32_u24 v4, 160, v4
  v_add_u32 v132, v4, v11
  ds_read_b64_tr_b16 a[0:1], v132 offset:0
  ds_read_b64_tr_b16 a[4:5], v132 offset:32
  ds_read_b64_tr_b16 a[8:9], v132 offset:64
  ds_read_b64_tr_b16 a[12:13], v132 offset:96
  ds_read_b64_tr_b16 a[16:17], v132 offset:128
  s_mov_b32 s29, 353637890
  s_mov_b32 s30, 50529027
  v_bfe_u32 v4, s29, v6, 8
  v_bfe_u32 v5, s30, v6, 8
  v_mad_u32_u24 v4, v5, v3, v4
  v_mul_u32_u24 v4, 160, v4
  v_add_u32 v133, v4, v11
  ds_read_b64_tr_b16 a[2:3], v133 offset:0
  ds_read_b64_tr_b16 a[6:7], v133 offset:32
  ds_read_b64_tr_b16 a[10:11], v133 offset:64
  ds_read_b64_tr_b16 a[14:15], v133 offset:96
  ds_read_b64_tr_b16 a[18:19], v133 offset:128
  s_mov_b32 s29, 690495776
  s_mov_b32 s30, 50528770
  v_bfe_u32 v4, s29, v6, 8
  v_bfe_u32 v5, s30, v6, 8
  v_mad_u32_u24 v4, v5, v3, v4
  v_mul_u32_u24 v4, 160, v4
  v_add_u32 v132, v4, v11
  ds_read_b64_tr_b16 a[20:21], v132 offset:0
  ds_read_b64_tr_b16 a[24:25], v132 offset:32
  ds_read_b64_tr_b16 a[28:29], v132 offset:64
  ds_read_b64_tr_b16 a[32:33], v132 offset:96
  ds_read_b64_tr_b16 a[36:37], v132 offset:128
  s_mov_b32 s29, 1042953524
  s_mov_b32 s30, 50528770
  v_bfe_u32 v4, s29, v6, 8
  v_bfe_u32 v5, s30, v6, 8
  v_mad_u32_u24 v4, v5, v3, v4
  v_mul_u32_u24 v4, 160, v4
  v_add_u32 v133, v4, v11
  ds_read_b64_tr_b16 a[22:23], v133 offset:0
  ds_read_b64_tr_b16 a[26:27], v133 offset:32
  ds_read_b64_tr_b16 a[30:31], v133 offset:64
  ds_read_b64_tr_b16 a[34:35], v133 offset:96
  ds_read_b64_tr_b16 a[38:39], v133 offset:128
  s_mov_b32 s29, 1229471036
  s_mov_b32 s30, 33686275
  v_bfe_u32 v4, s29, v6, 8
  v_bfe_u32 v5, s30, v6, 8
  v_mad_u32_u24 v4, v5, v3, v4
  v_mul_u32_u24 v4, 160, v4
  v_add_u32 v132, v4, v11
  ds_read_b64_tr_b16 a[40:41], v132 offset:0
  ds_read_b64_tr_b16 a[44:45], v132 offset:32
  ds_read_b64_tr_b16 a[48:49], v132 offset:64
  ds_read_b64_tr_b16 a[52:53], v132 offset:96
  ds_read_b64_tr_b16 a[56:57], v132 offset:128
  s_mov_b32 s29, 1566331216
  s_mov_b32 s30, 33686275
  v_bfe_u32 v4, s29, v6, 8
  v_bfe_u32 v5, s30, v6, 8
  v_mad_u32_u24 v4, v5, v3, v4
  v_mul_u32_u24 v4, 160, v4
  v_add_u32 v133, v4, v11
  ds_read_b64_tr_b16 a[42:43], v133 offset:0
  ds_read_b64_tr_b16 a[46:47], v133 offset:32
  ds_read_b64_tr_b16 a[50:51], v133 offset:64
  ds_read_b64_tr_b16 a[54:55], v133 offset:96
  ds_read_b64_tr_b16 a[58:59], v133 offset:128
  s_mov_b32 s29, 1701078610
  s_mov_b32 s30, 50529027
  v_bfe_u32 v4, s29, v6, 8
  v_bfe_u32 v5, s30, v6, 8
  v_mad_u32_u24 v4, v5, v3, v4
  v_mul_u32_u24 v4, 160, v4
  v_add_u32 v132, v4, v11
  ds_read_b64_tr_b16 a[60:61], v132 offset:0
  ds_read_b64_tr_b16 a[64:65], v132 offset:32
  ds_read_b64_tr_b16 a[68:69], v132 offset:64
  ds_read_b64_tr_b16 a[72:73], v132 offset:96
  ds_read_b64_tr_b16 a[76:77], v132 offset:128
  s_mov_b32 s29, 2037936496
  s_mov_b32 s30, 50528770
  v_bfe_u32 v4, s29, v6, 8
  v_bfe_u32 v5, s30, v6, 8
  v_mad_u32_u24 v4, v5, v3, v4
  v_mul_u32_u24 v4, 160, v4
  v_add_u32 v133, v4, v11
  ds_read_b64_tr_b16 a[62:63], v133 offset:0
  ds_read_b64_tr_b16 a[66:67], v133 offset:32
  ds_read_b64_tr_b16 a[70:71], v133 offset:64
  ds_read_b64_tr_b16 a[74:75], v133 offset:96
  ds_read_b64_tr_b16 a[78:79], v133 offset:128
  s_mov_b32 s29, 2390394244
  s_mov_b32 s30, 50528770
  v_bfe_u32 v4, s29, v6, 8
  v_bfe_u32 v5, s30, v6, 8
  v_mad_u32_u24 v4, v5, v3, v4
  v_mul_u32_u24 v4, 160, v4
  v_add_u32 v132, v4, v11
  ds_read_b64_tr_b16 a[80:81], v132 offset:0
  ds_read_b64_tr_b16 a[84:85], v132 offset:32
  ds_read_b64_tr_b16 a[88:89], v132 offset:64
  ds_read_b64_tr_b16 a[92:93], v132 offset:96
  ds_read_b64_tr_b16 a[96:97], v132 offset:128
  s_mov_b32 s29, 2576911756
  s_mov_b32 s30, 33686275
  v_bfe_u32 v4, s29, v6, 8
  v_bfe_u32 v5, s30, v6, 8
  v_mad_u32_u24 v4, v5, v3, v4
  v_mul_u32_u24 v4, 160, v4
  v_add_u32 v133, v4, v11
  ds_read_b64_tr_b16 a[82:83], v133 offset:0
  ds_read_b64_tr_b16 a[86:87], v133 offset:32
  ds_read_b64_tr_b16 a[90:91], v133 offset:64
  ds_read_b64_tr_b16 a[94:95], v133 offset:96
  ds_read_b64_tr_b16 a[98:99], v133 offset:128
  v_lshrrev_b32 v4, 2, v2
  v_and_b32 v5, 3, v2
  v_min_u32 v6, 2, v3
  v_lshl_add_u32 v6, v6, 4, s35
  v_mad_u32_u24 v10, v4, 3, v5
  v_cmp_eq_u32 vcc, 3, v5
  s_nop 1
  v_cndmask_b32 v10, v10, 20, vcc
  v_mad_u32_u24 v10, v10, 40, v6
  v_lshl_add_u32 v11, v4, 1, v5
  v_add_u32 v11, 12, v11
  v_cmp_lt_u32 vcc, 1, v5
  s_nop 1
  v_cndmask_b32 v11, v11, 20, vcc
  v_mad_u32_u24 v11, v11, 40, v6
  v_cmp_gt_u32 vcc, 2, v3
  s_nop 1
  v_cndmask_b32 v8, 0, -1, vcc
  v_lshl_add_u32 v9, v1, 3, s35
  s_mov_b32 s58, 897988541
  s_waitcnt lgkmcnt(0)
  s_waitcnt vmcnt(29)
  s_barrier
  s_cmp_lg_u32 s28, 0
  s_cbranch_scc1 L_f_sg_72
  v_mov_b32 v4, s88
  v_mov_b32 v5, s52
  s_mov_b64 exec, 1
  global_store_dword v4, v5, s[50:51] sc0 sc1
  s_mov_b64 exec, -1
L_f_sg_72:
  v_cvt_pk_bf16_f32 v76, v76, v77
  v_cvt_pk_bf16_f32 v77, v78, v79
  ds_write_b64 v9, v[76:77] offset:0
  s_waitcnt vmcnt(28)
  v_cvt_pk_bf16_f32 v80, v80, v81
  v_cvt_pk_bf16_f32 v81, v82, v83
  ds_write_b64 v9, v[80:81] offset:512
  s_waitcnt vmcnt(27)
  v_cvt_pk_bf16_f32 v84, v84, v85
  v_cvt_pk_bf16_f32 v85, v86, v87
  ds_write_b64 v9, v[84:85] offset:1024
  s_waitcnt vmcnt(26)
  v_cvt_pk_bf16_f32 v88, v88, v89
  v_cvt_pk_bf16_f32 v89, v90, v91
  ds_write_b64 v9, v[88:89] offset:1536
  s_waitcnt vmcnt(25)
  v_cvt_pk_bf16_f32 v92, v92, v93
  v_cvt_pk_bf16_f32 v93, v94, v95
  ds_write_b64 v9, v[92:93] offset:2048
  s_waitcnt vmcnt(24)
  v_cvt_pk_bf16_f32 v96, v96, v97
  v_cvt_pk_bf16_f32 v97, v98, v99
  ds_write_b64 v9, v[96:97] offset:2560
  s_waitcnt vmcnt(23)
  v_cvt_pk_bf16_f32 v100, v100, v101
  v_cvt_pk_bf16_f32 v101, v102, v103
  ds_write_b64 v9, v[100:101] offset:3072
  s_waitcnt vmcnt(22)
  v_cvt_pk_bf16_f32 v104, v104, v105
  v_cvt_pk_bf16_f32 v105, v106, v107
  ds_write_b64 v9, v[104:105] offset:3584
  s_waitcnt vmcnt(21)
  v_cvt_pk_bf16_f32 v108, v108, v109
  v_cvt_pk_bf16_f32 v109, v110, v111
  ds_write_b64 v9, v[108:109] offset:4096
  s_waitcnt vmcnt(20)
  v_cvt_pk_bf16_f32 v112, v112, v113
  v_cvt_pk_bf16_f32 v113, v114, v115
  ds_write_b64 v9, v[112:113] offset:4608
  s_waitcnt vmcnt(19)
  v_cvt_pk_bf16_f32 v116, v116, v117
  v_cvt_pk_bf16_f32 v117, v118, v119
  ds_write_b64 v9, v[116:117] offset:5120
  s_waitcnt vmcnt(18)
  v_cvt_pk_bf16_f32 v120, v120, v121
  v_cvt_pk_bf16_f32 v121, v122, v123
  ds_write_b64 v9, v[120:121] offset:5632
  s_waitcnt vmcnt(17)
  v_cvt_pk_bf16_f32 v124, v124, v125
  v_cvt_pk_bf16_f32 v125, v126, v127
  ds_write_b64 v9, v[124:125] offset:6144
  s_waitcnt vmcnt(16)
  v_cvt_pk_bf16_f32 v128, v128, v129
  v_cvt_pk_bf16_f32 v129, v130, v131
  ds_write_b64 v9, v[128:129] offset:6656
  ds_read2_b64 v[76:79], v10 offset0:0 offset1:1
  ds_read2_b64 v[80:83], v11 offset0:0 offset1:1
  ds_read2_b64 v[84:87], v10 offset0:105 offset1:106
  ds_read2_b64 v[88:91], v11 offset0:105 offset1:106
  v_add_u32 v10, 1680, v10
  v_add_u32 v11, 1680, v11
  ds_read2_b64 v[92:95], v10 offset0:0 offset1:1
  ds_read2_b64 v[96:99], v11 offset0:0 offset1:1
  ds_read2_b64 v[100:103], v10 offset0:105 offset1:106
  ds_read2_b64 v[104:107], v11 offset0:105 offset1:106
  v_add_u32 v10, 1680, v10
  v_add_u32 v11, 1680, v11
  ds_read2_b64 v[108:111], v10 offset0:0 offset1:1
  ds_read2_b64 v[112:115], v11 offset0:0 offset1:1
  ds_read2_b64 v[116:119], v10 offset0:105 offset1:106
  ds_read2_b64 v[120:123], v11 offset0:105 offset1:106
  v_add_u32 v10, 1680, v10
  v_add_u32 v11, 1680, v11
  ds_read2_b64 v[124:127], v10 offset0:0 offset1:1
  ds_read2_b64 v[128:131], v11 offset0:0 offset1:1
  ds_read2_b64 v[132:135], v10 offset0:105 offset1:106
  ds_read2_b64 v[136:139], v11 offset0:105 offset1:106
  s_waitcnt vmcnt(14)
  s_waitcnt lgkmcnt(12)
  v_mfma_f32_16x16x32_bf16 v[140:143], v[76:79], v[12:15], 0
  v_mfma_f32_16x16x32_bf16 v[144:147], v[80:83], v[12:15], 0
  v_mfma_f32_16x16x32_bf16 v[148:151], v[84:87], v[16:19], 0
  v_mfma_f32_16x16x32_bf16 v[152:155], v[88:91], v[16:19], 0
  s_mov_b64 exec, s[62:63]
  buffer_load_dwordx4 v[12:15], v7, s[20:23], s42 offen offset:0
  buffer_load_dwordx4 v[16:19], v7, s[20:23], s42 offen offset:768
  s_mov_b64 exec, -1
  v_lshl_add_u32 v231, v1, 4, s35
  s_mul_i32 s29, s4, 160
  s_add_u32 s29, s29, 8131584
  v_min_u32 v244, 39, v1
  v_lshl_add_u32 v244, v244, 2, s29
  s_lshr_b32 s29, s3, 1
  s_lshl_b32 s29, s29, 2
  s_add_u32 s29, s29, 8126464
  v_and_b32 v245, 3, v1
  v_lshl_add_u32 v245, v245, 6, s29
  v_lshrrev_b32 v4, 2, v2
  v_lshl_add_u32 v4, v3, 2, v4
  v_add_f32 v216, s58, v143
  v_rcp_f32 v216, v216
  s_nop 0
  v_pk_mul_f32 v[140:141], v[140:141], v[216:217] op_sel:[0,0] op_sel_hi:[1,0]
  v_mul_f32 v142, v142, v216
  v_pk_mul_f32 v[144:145], v[144:145], v[216:217] op_sel:[0,0] op_sel_hi:[1,0]
  v_cvt_pk_bf16_f32 v156, v140, v141
  v_cvt_pk_bf16_f32 v157, v144, v145
  v_add_f32 v218, s58, v151
  v_rcp_f32 v218, v218
  s_nop 0
  v_pk_mul_f32 v[148:149], v[148:149], v[218:219] op_sel:[0,0] op_sel_hi:[1,0]
  v_mul_f32 v150, v150, v218
  v_pk_mul_f32 v[152:153], v[152:153], v[218:219] op_sel:[0,0] op_sel_hi:[1,0]
  v_cvt_pk_bf16_f32 v158, v142, v150
  v_cvt_pk_bf16_f32 v159, v148, v149
  v_cvt_pk_bf16_f32 v160, v152, v153
  s_waitcnt vmcnt(14)
  s_waitcnt lgkmcnt(8)
  v_mfma_f32_16x16x32_bf16 v[140:143], v[92:95], v[20:23], 0
  v_mfma_f32_16x16x32_bf16 v[144:147], v[96:99], v[20:23], 0
  v_mfma_f32_16x16x32_bf16 v[148:151], v[100:103], v[24:27], 0
  v_mfma_f32_16x16x32_bf16 v[152:155], v[104:107], v[24:27], 0
  s_mov_b64 exec, s[62:63]
  buffer_load_dwordx4 v[20:23], v7, s[20:23], s42 offen offset:1536
  buffer_load_dwordx4 v[24:27], v7, s[20:23], s42 offen offset:2304
  s_mov_b64 exec, -1
  v_lshlrev_b32 v4, 7, v4
  v_and_b32 v5, 3, v2
  v_lshl_add_u32 v4, v5, 3, v4
  s_lshl_b32 s29, s28, 5
  s_add_u32 s29, s29, 102400
  v_add_u32 v221, s29, v4
  s_lshl_b32 s29, s3, 6
  s_lshl_b32 s30, s28, 4
  s_add_u32 s29, s29, s30
  v_add_u32 v5, s29, v2
  v_lshlrev_b32 v230, 2, v5
  v_add_u32 v230, 7929856, v230
  v_add_f32 v216, s58, v143
  v_rcp_f32 v216, v216
  s_nop 0
  v_pk_mul_f32 v[140:141], v[140:141], v[216:217] op_sel:[0,0] op_sel_hi:[1,0]
  v_mul_f32 v142, v142, v216
  v_pk_mul_f32 v[144:145], v[144:145], v[216:217] op_sel:[0,0] op_sel_hi:[1,0]
  v_cvt_pk_bf16_f32 v161, v140, v141
  v_cvt_pk_bf16_f32 v162, v144, v145
  v_add_f32 v218, s58, v151
  v_rcp_f32 v218, v218
  s_nop 0
  v_pk_mul_f32 v[148:149], v[148:149], v[218:219] op_sel:[0,0] op_sel_hi:[1,0]
  v_mul_f32 v150, v150, v218
  v_pk_mul_f32 v[152:153], v[152:153], v[218:219] op_sel:[0,0] op_sel_hi:[1,0]
  v_cvt_pk_bf16_f32 v163, v142, v150
  v_cvt_pk_bf16_f32 v164, v148, v149
  v_cvt_pk_bf16_f32 v165, v152, v153
  s_waitcnt vmcnt(14)
  s_waitcnt lgkmcnt(4)
  v_mfma_f32_16x16x32_bf16 v[140:143], v[108:111], v[28:31], 0
  v_mfma_f32_16x16x32_bf16 v[144:147], v[112:115], v[28:31], 0
  v_mfma_f32_16x16x32_bf16 v[148:151], v[116:119], v[32:35], 0
  v_mfma_f32_16x16x32_bf16 v[152:155], v[120:123], v[32:35], 0
  s_mov_b64 exec, s[62:63]
  buffer_load_dwordx4 v[28:31], v7, s[20:23], s26 offen offset:0
  buffer_load_dwordx4 v[32:35], v7, s[20:23], s26 offen offset:768
  s_mov_b64 exec, -1
  v_mul_u32_u24 v5, 1280, v5
  s_mul_i32 s29, s4, 160
  v_lshl_add_u32 v222, v3, 3, v5
  v_add_u32 v222, s29, v222
  v_and_b32 v4, 1, v3
  v_lshl_add_u32 v5, v4, 5, v5
  v_lshrrev_b32 v4, 1, v3
  v_lshl_add_u32 v5, v4, 4, v5
  v_add_u32 v223, s29, v5
  s_mul_i32 s29, s28, 160
  v_add_u32 v4, s29, v1
  v_lshrrev_b32 v5, 3, v4
  v_add_f32 v216, s58, v143
  v_rcp_f32 v216, v216
  s_nop 0
  v_pk_mul_f32 v[140:141], v[140:141], v[216:217] op_sel:[0,0] op_sel_hi:[1,0]
  v_mul_f32 v142, v142, v216
  v_pk_mul_f32 v[144:145], v[144:145], v[216:217] op_sel:[0,0] op_sel_hi:[1,0]
  v_cvt_pk_bf16_f32 v166, v140, v141
  v_cvt_pk_bf16_f32 v167, v144, v145
  v_add_f32 v218, s58, v151
  v_rcp_f32 v218, v218
  s_nop 0
  v_pk_mul_f32 v[148:149], v[148:149], v[218:219] op_sel:[0,0] op_sel_hi:[1,0]
  v_mul_f32 v150, v150, v218
  v_pk_mul_f32 v[152:153], v[152:153], v[218:219] op_sel:[0,0] op_sel_hi:[1,0]
  v_cvt_pk_bf16_f32 v168, v142, v150
  v_cvt_pk_bf16_f32 v169, v148, v149
  v_cvt_pk_bf16_f32 v170, v152, v153
  s_waitcnt vmcnt(14)
  s_waitcnt lgkmcnt(0)
  v_mfma_f32_16x16x32_bf16 v[140:143], v[124:127], v[36:39], 0
  v_mfma_f32_16x16x32_bf16 v[144:147], v[128:131], v[36:39], 0
  v_mfma_f32_16x16x32_bf16 v[148:151], v[132:135], v[40:43], 0
  v_mfma_f32_16x16x32_bf16 v[152:155], v[136:139], v[40:43], 0
  s_mov_b64 exec, s[62:63]
  buffer_load_dwordx4 v[36:39], v7, s[20:23], s26 offen offset:1536
  buffer_load_dwordx4 v[40:43], v7, s[20:23], s26 offen offset:2304
  s_mov_b64 exec, -1
  v_and_b32 v4, 7, v4
  v_lshlrev_b32 v5, 12, v5
  v_lshl_add_u32 v4, v4, 4, v5
  s_mul_i32 s29, s4, 327680
  s_lshl_b32 s30, s3, 7
  s_add_u32 s29, s29, s30
  s_add_u32 s29, s29, 0
  v_add_u32 v228, s29, v4
  s_mul_i32 s30, s28, 2560
  s_add_u32 s30, s30, 102400
  v_lshl_add_u32 v229, v1, 4, s30
  v_add_f32 v216, s58, v143
  v_rcp_f32 v216, v216
  s_nop 0
  v_pk_mul_f32 v[140:141], v[140:141], v[216:217] op_sel:[0,0] op_sel_hi:[1,0]
  v_mul_f32 v142, v142, v216
  v_pk_mul_f32 v[144:145], v[144:145], v[216:217] op_sel:[0,0] op_sel_hi:[1,0]
  v_cvt_pk_bf16_f32 v171, v140, v141
  v_cvt_pk_bf16_f32 v172, v144, v145
  v_add_f32 v218, s58, v151
  v_rcp_f32 v218, v218
  s_nop 0
  v_pk_mul_f32 v[148:149], v[148:149], v[218:219] op_sel:[0,0] op_sel_hi:[1,0]
  v_mul_f32 v150, v150, v218
  v_pk_mul_f32 v[152:153], v[152:153], v[218:219] op_sel:[0,0] op_sel_hi:[1,0]
  v_cvt_pk_bf16_f32 v173, v142, v150
  v_cvt_pk_bf16_f32 v174, v148, v149
  v_cvt_pk_bf16_f32 v175, v152, v153
  s_waitcnt vmcnt(14)
  v_mfma_f32_16x16x32_bf16 v[140:143], v[76:79], v[44:47], 0
  v_mfma_f32_16x16x32_bf16 v[144:147], v[80:83], v[44:47], 0
  v_mfma_f32_16x16x32_bf16 v[148:151], v[84:87], v[48:51], 0
  v_mfma_f32_16x16x32_bf16 v[152:155], v[88:91], v[48:51], 0
  s_mov_b64 exec, s[62:63]
  buffer_load_dwordx4 v[44:47], v7, s[20:23], s43 offen offset:0
  buffer_load_dwordx4 v[48:51], v7, s[20:23], s43 offen offset:768
  s_mov_b64 exec, -1
  v_mfma_f32_16x16x32_bf16 v[196:199], a[0:3], v[156:159], 0
  v_mfma_f32_16x16x32_bf16 v[196:199], a[20:23], v[160:163], v[196:199]
  v_mfma_f32_16x16x32_bf16 v[196:199], a[40:43], v[164:167], v[196:199]
  v_add_f32 v216, s58, v143
  v_rcp_f32 v216, v216
  s_nop 0
  v_pk_mul_f32 v[140:141], v[140:141], v[216:217] op_sel:[0,0] op_sel_hi:[1,0]
  v_mul_f32 v142, v142, v216
  v_pk_mul_f32 v[144:145], v[144:145], v[216:217] op_sel:[0,0] op_sel_hi:[1,0]
  v_cvt_pk_bf16_f32 v176, v140, v141
  v_cvt_pk_bf16_f32 v177, v144, v145
  v_mfma_f32_16x16x32_bf16 v[196:199], a[60:63], v[168:171], v[196:199]
  v_mfma_f32_16x16x32_bf16 v[196:199], a[80:83], v[172:175], v[196:199]
  v_add_f32 v218, s58, v151
  v_rcp_f32 v218, v218
  s_nop 0
  v_pk_mul_f32 v[148:149], v[148:149], v[218:219] op_sel:[0,0] op_sel_hi:[1,0]
  v_mul_f32 v150, v150, v218
  v_pk_mul_f32 v[152:153], v[152:153], v[218:219] op_sel:[0,0] op_sel_hi:[1,0]
  v_cvt_pk_bf16_f32 v178, v142, v150
  v_cvt_pk_bf16_f32 v179, v148, v149
  v_cvt_pk_bf16_f32 v180, v152, v153
  v_mfma_f32_16x16x32_bf16 v[200:203], a[4:7], v[156:159], 0
  s_waitcnt vmcnt(14)
  v_mfma_f32_16x16x32_bf16 v[140:143], v[92:95], v[52:55], 0
  v_mfma_f32_16x16x32_bf16 v[144:147], v[96:99], v[52:55], 0
  v_mfma_f32_16x16x32_bf16 v[148:151], v[100:103], v[56:59], 0
  v_mfma_f32_16x16x32_bf16 v[152:155], v[104:107], v[56:59], 0
  s_mov_b64 exec, s[62:63]
  buffer_load_dwordx4 v[52:55], v7, s[20:23], s43 offen offset:1536
  buffer_load_dwordx4 v[56:59], v7, s[20:23], s43 offen offset:2304
  s_mov_b64 exec, -1
  v_mfma_f32_16x16x32_bf16 v[200:203], a[24:27], v[160:163], v[200:203]
  v_mfma_f32_16x16x32_bf16 v[200:203], a[44:47], v[164:167], v[200:203]
  ds_write_b128 v231, v[196:199] offset:8192
  v_mfma_f32_16x16x32_bf16 v[200:203], a[64:67], v[168:171], v[200:203]
  v_add_f32 v216, s58, v143
  v_rcp_f32 v216, v216
  s_nop 0
  v_pk_mul_f32 v[140:141], v[140:141], v[216:217] op_sel:[0,0] op_sel_hi:[1,0]
  v_mul_f32 v142, v142, v216
  v_pk_mul_f32 v[144:145], v[144:145], v[216:217] op_sel:[0,0] op_sel_hi:[1,0]
  v_cvt_pk_bf16_f32 v181, v140, v141
  v_cvt_pk_bf16_f32 v182, v144, v145
  v_mfma_f32_16x16x32_bf16 v[200:203], a[84:87], v[172:175], v[200:203]
  v_mfma_f32_16x16x32_bf16 v[204:207], a[8:11], v[156:159], 0
  v_add_f32 v218, s58, v151
  v_rcp_f32 v218, v218
  s_nop 0
  v_pk_mul_f32 v[148:149], v[148:149], v[218:219] op_sel:[0,0] op_sel_hi:[1,0]
  v_mul_f32 v150, v150, v218
  v_pk_mul_f32 v[152:153], v[152:153], v[218:219] op_sel:[0,0] op_sel_hi:[1,0]
  v_cvt_pk_bf16_f32 v183, v142, v150
  v_cvt_pk_bf16_f32 v184, v148, v149
  v_cvt_pk_bf16_f32 v185, v152, v153
  v_mfma_f32_16x16x32_bf16 v[204:207], a[28:31], v[160:163], v[204:207]
  s_waitcnt vmcnt(14)
  v_mfma_f32_16x16x32_bf16 v[140:143], v[108:111], v[60:63], 0
  v_mfma_f32_16x16x32_bf16 v[144:147], v[112:115], v[60:63], 0
  v_mfma_f32_16x16x32_bf16 v[148:151], v[116:119], v[64:67], 0
  v_mfma_f32_16x16x32_bf16 v[152:155], v[120:123], v[64:67], 0
  s_mov_b64 exec, s[62:63]
  buffer_load_dwordx4 v[60:63], v7, s[20:23], s27 offen offset:0
  buffer_load_dwordx4 v[64:67], v7, s[20:23], s27 offen offset:768
  s_mov_b64 exec, -1
  v_mfma_f32_16x16x32_bf16 v[204:207], a[48:51], v[164:167], v[204:207]
  ds_write_b128 v231, v[200:203] offset:9216
  v_mfma_f32_16x16x32_bf16 v[204:207], a[68:71], v[168:171], v[204:207]
  v_mfma_f32_16x16x32_bf16 v[204:207], a[88:91], v[172:175], v[204:207]
  v_add_f32 v216, s58, v143
  v_rcp_f32 v216, v216
  s_nop 0
  v_pk_mul_f32 v[140:141], v[140:141], v[216:217] op_sel:[0,0] op_sel_hi:[1,0]
  v_mul_f32 v142, v142, v216
  v_pk_mul_f32 v[144:145], v[144:145], v[216:217] op_sel:[0,0] op_sel_hi:[1,0]
  v_cvt_pk_bf16_f32 v186, v140, v141
  v_cvt_pk_bf16_f32 v187, v144, v145
  v_mfma_f32_16x16x32_bf16 v[208:211], a[12:15], v[156:159], 0
  v_mfma_f32_16x16x32_bf16 v[208:211], a[32:35], v[160:163], v[208:211]
  v_add_f32 v218, s58, v151
  v_rcp_f32 v218, v218
  s_nop 0
  v_pk_mul_f32 v[148:149], v[148:149], v[218:219] op_sel:[0,0] op_sel_hi:[1,0]
  v_mul_f32 v150, v150, v218
  v_pk_mul_f32 v[152:153], v[152:153], v[218:219] op_sel:[0,0] op_sel_hi:[1,0]
  v_cvt_pk_bf16_f32 v188, v142, v150
  v_cvt_pk_bf16_f32 v189, v148, v149
  v_cvt_pk_bf16_f32 v190, v152, v153
  v_mfma_f32_16x16x32_bf16 v[208:211], a[52:55], v[164:167], v[208:211]
  ds_write_b128 v231, v[204:207] offset:10240
  s_waitcnt vmcnt(14)
  v_mfma_f32_16x16x32_bf16 v[140:143], v[124:127], v[68:71], 0
  v_mfma_f32_16x16x32_bf16 v[144:147], v[128:131], v[68:71], 0
  v_mfma_f32_16x16x32_bf16 v[148:151], v[132:135], v[72:75], 0
  v_mfma_f32_16x16x32_bf16 v[152:155], v[136:139], v[72:75], 0
  s_mov_b64 exec, s[62:63]
  buffer_load_dwordx4 v[68:71], v7, s[20:23], s27 offen offset:1536
  buffer_load_dwordx4 v[72:75], v7, s[20:23], s27 offen offset:2304
  s_mov_b64 exec, -1
  v_mfma_f32_16x16x32_bf16 v[208:211], a[72:75], v[168:171], v[208:211]
  v_mfma_f32_16x16x32_bf16 v[208:211], a[92:95], v[172:175], v[208:211]
  v_mfma_f32_16x16x32_bf16 v[212:215], a[16:19], v[156:159], 0
  v_add_f32 v216, s58, v143
  v_rcp_f32 v216, v216
  s_nop 0
  v_pk_mul_f32 v[140:141], v[140:141], v[216:217] op_sel:[0,0] op_sel_hi:[1,0]
  v_mul_f32 v142, v142, v216
  v_pk_mul_f32 v[144:145], v[144:145], v[216:217] op_sel:[0,0] op_sel_hi:[1,0]
  v_cvt_pk_bf16_f32 v191, v140, v141
  v_cvt_pk_bf16_f32 v192, v144, v145
  v_mfma_f32_16x16x32_bf16 v[212:215], a[36:39], v[160:163], v[212:215]
  v_mfma_f32_16x16x32_bf16 v[212:215], a[56:59], v[164:167], v[212:215]
  ds_write_b128 v231, v[208:211] offset:11264
  v_add_f32 v218, s58, v151
  v_rcp_f32 v218, v218
  s_nop 0
  v_pk_mul_f32 v[148:149], v[148:149], v[218:219] op_sel:[0,0] op_sel_hi:[1,0]
  v_mul_f32 v150, v150, v218
  v_pk_mul_f32 v[152:153], v[152:153], v[218:219] op_sel:[0,0] op_sel_hi:[1,0]
  v_cvt_pk_bf16_f32 v193, v142, v150
  v_cvt_pk_bf16_f32 v194, v148, v149
  v_cvt_pk_bf16_f32 v195, v152, v153
  v_mfma_f32_16x16x32_bf16 v[212:215], a[76:79], v[168:171], v[212:215]
  v_mfma_f32_16x16x32_bf16 v[212:215], a[96:99], v[172:175], v[212:215]
  s_nop 7
  ds_write_b128 v231, v[212:215] offset:12288
  s_waitcnt vmcnt(14)
  v_mfma_f32_16x16x32_bf16 v[140:143], v[76:79], v[12:15], 0
  v_mfma_f32_16x16x32_bf16 v[144:147], v[80:83], v[12:15], 0
  v_mfma_f32_16x16x32_bf16 v[148:151], v[84:87], v[16:19], 0
  v_mfma_f32_16x16x32_bf16 v[152:155], v[88:91], v[16:19], 0
  v_mfma_f32_16x16x32_bf16 v[196:199], a[0:3], v[176:179], 0
  v_mfma_f32_16x16x32_bf16 v[196:199], a[20:23], v[180:183], v[196:199]
  v_mfma_f32_16x16x32_bf16 v[196:199], a[40:43], v[184:187], v[196:199]
  s_nop 1
  v_add_f32 v216, s58, v143
  v_rcp_f32 v216, v216
  s_nop 0
  v_pk_mul_f32 v[140:141], v[140:141], v[216:217] op_sel:[0,0] op_sel_hi:[1,0]
  v_mul_f32 v142, v142, v216
  v_pk_mul_f32 v[144:145], v[144:145], v[216:217] op_sel:[0,0] op_sel_hi:[1,0]
  v_cvt_pk_bf16_f32 v156, v140, v141
  v_cvt_pk_bf16_f32 v157, v144, v145
  v_mfma_f32_16x16x32_bf16 v[196:199], a[60:63], v[188:191], v[196:199]
  v_mfma_f32_16x16x32_bf16 v[196:199], a[80:83], v[192:195], v[196:199]
  v_add_f32 v218, s58, v151
  v_rcp_f32 v218, v218
  s_nop 0
  v_pk_mul_f32 v[148:149], v[148:149], v[218:219] op_sel:[0,0] op_sel_hi:[1,0]
  v_mul_f32 v150, v150, v218
  v_pk_mul_f32 v[152:153], v[152:153], v[218:219] op_sel:[0,0] op_sel_hi:[1,0]
  v_cvt_pk_bf16_f32 v158, v142, v150
  v_cvt_pk_bf16_f32 v159, v148, v149
  v_cvt_pk_bf16_f32 v160, v152, v153
  v_mfma_f32_16x16x32_bf16 v[200:203], a[4:7], v[176:179], 0
  s_waitcnt vmcnt(12)
  v_mfma_f32_16x16x32_bf16 v[140:143], v[92:95], v[20:23], 0
  v_mfma_f32_16x16x32_bf16 v[144:147], v[96:99], v[20:23], 0
  v_mfma_f32_16x16x32_bf16 v[148:151], v[100:103], v[24:27], 0
  v_mfma_f32_16x16x32_bf16 v[152:155], v[104:107], v[24:27], 0
  v_mfma_f32_16x16x32_bf16 v[200:203], a[24:27], v[180:183], v[200:203]
  v_mfma_f32_16x16x32_bf16 v[200:203], a[44:47], v[184:187], v[200:203]
  ds_write_b128 v231, v[196:199] offset:13312
  v_mfma_f32_16x16x32_bf16 v[200:203], a[64:67], v[188:191], v[200:203]
  s_nop 0
  v_add_f32 v216, s58, v143
  v_rcp_f32 v216, v216
  s_nop 0
  v_pk_mul_f32 v[140:141], v[140:141], v[216:217] op_sel:[0,0] op_sel_hi:[1,0]
  v_mul_f32 v142, v142, v216
  v_pk_mul_f32 v[144:145], v[144:145], v[216:217] op_sel:[0,0] op_sel_hi:[1,0]
  v_cvt_pk_bf16_f32 v161, v140, v141
  v_cvt_pk_bf16_f32 v162, v144, v145
  v_mfma_f32_16x16x32_bf16 v[200:203], a[84:87], v[192:195], v[200:203]
  v_mfma_f32_16x16x32_bf16 v[204:207], a[8:11], v[176:179], 0
  v_add_f32 v218, s58, v151
  v_rcp_f32 v218, v218
  s_nop 0
  v_pk_mul_f32 v[148:149], v[148:149], v[218:219] op_sel:[0,0] op_sel_hi:[1,0]
  v_mul_f32 v150, v150, v218
  v_pk_mul_f32 v[152:153], v[152:153], v[218:219] op_sel:[0,0] op_sel_hi:[1,0]
  v_cvt_pk_bf16_f32 v163, v142, v150
  v_cvt_pk_bf16_f32 v164, v148, v149
  v_cvt_pk_bf16_f32 v165, v152, v153
  v_mfma_f32_16x16x32_bf16 v[204:207], a[28:31], v[180:183], v[204:207]
  s_waitcnt vmcnt(10)
  v_mfma_f32_16x16x32_bf16 v[140:143], v[108:111], v[28:31], 0
  v_mfma_f32_16x16x32_bf16 v[144:147], v[112:115], v[28:31], 0
  v_mfma_f32_16x16x32_bf16 v[148:151], v[116:119], v[32:35], 0
  v_mfma_f32_16x16x32_bf16 v[152:155], v[120:123], v[32:35], 0
  v_mfma_f32_16x16x32_bf16 v[204:207], a[48:51], v[184:187], v[204:207]
  ds_write_b128 v231, v[200:203] offset:14336
  v_mfma_f32_16x16x32_bf16 v[204:207], a[68:71], v[188:191], v[204:207]
  v_mfma_f32_16x16x32_bf16 v[204:207], a[88:91], v[192:195], v[204:207]
  s_nop 0
  v_add_f32 v216, s58, v143
  v_rcp_f32 v216, v216
  s_nop 0
  v_pk_mul_f32 v[140:141], v[140:141], v[216:217] op_sel:[0,0] op_sel_hi:[1,0]
  v_mul_f32 v142, v142, v216
  v_pk_mul_f32 v[144:145], v[144:145], v[216:217] op_sel:[0,0] op_sel_hi:[1,0]
  v_cvt_pk_bf16_f32 v166, v140, v141
  v_cvt_pk_bf16_f32 v167, v144, v145
  v_mfma_f32_16x16x32_bf16 v[208:211], a[12:15], v[176:179], 0
  v_mfma_f32_16x16x32_bf16 v[208:211], a[32:35], v[180:183], v[208:211]
  v_add_f32 v218, s58, v151
  v_rcp_f32 v218, v218
  s_nop 0
  v_pk_mul_f32 v[148:149], v[148:149], v[218:219] op_sel:[0,0] op_sel_hi:[1,0]
  v_mul_f32 v150, v150, v218
  v_pk_mul_f32 v[152:153], v[152:153], v[218:219] op_sel:[0,0] op_sel_hi:[1,0]
  v_cvt_pk_bf16_f32 v168, v142, v150
  v_cvt_pk_bf16_f32 v169, v148, v149
  v_cvt_pk_bf16_f32 v170, v152, v153
  v_mfma_f32_16x16x32_bf16 v[208:211], a[52:55], v[184:187], v[208:211]
  ds_write_b128 v231, v[204:207] offset:15360
  s_waitcnt vmcnt(8)
  v_mfma_f32_16x16x32_bf16 v[140:143], v[124:127], v[36:39], 0
  v_mfma_f32_16x16x32_bf16 v[144:147], v[128:131], v[36:39], 0
  v_mfma_f32_16x16x32_bf16 v[148:151], v[132:135], v[40:43], 0
  v_mfma_f32_16x16x32_bf16 v[152:155], v[136:139], v[40:43], 0
  v_mfma_f32_16x16x32_bf16 v[208:211], a[72:75], v[188:191], v[208:211]
  v_mfma_f32_16x16x32_bf16 v[208:211], a[92:95], v[192:195], v[208:211]
  v_mfma_f32_16x16x32_bf16 v[212:215], a[16:19], v[176:179], 0
  s_nop 1
  v_add_f32 v216, s58, v143
  v_rcp_f32 v216, v216
  s_nop 0
  v_pk_mul_f32 v[140:141], v[140:141], v[216:217] op_sel:[0,0] op_sel_hi:[1,0]
  v_mul_f32 v142, v142, v216
  v_pk_mul_f32 v[144:145], v[144:145], v[216:217] op_sel:[0,0] op_sel_hi:[1,0]
  v_cvt_pk_bf16_f32 v171, v140, v141
  v_cvt_pk_bf16_f32 v172, v144, v145
  v_mfma_f32_16x16x32_bf16 v[212:215], a[36:39], v[180:183], v[212:215]
  v_mfma_f32_16x16x32_bf16 v[212:215], a[56:59], v[184:187], v[212:215]
  ds_write_b128 v231, v[208:211] offset:16384
  v_add_f32 v218, s58, v151
  v_rcp_f32 v218, v218
  s_nop 0
  v_pk_mul_f32 v[148:149], v[148:149], v[218:219] op_sel:[0,0] op_sel_hi:[1,0]
  v_mul_f32 v150, v150, v218
  v_pk_mul_f32 v[152:153], v[152:153], v[218:219] op_sel:[0,0] op_sel_hi:[1,0]
  v_cvt_pk_bf16_f32 v173, v142, v150
  v_cvt_pk_bf16_f32 v174, v148, v149
  v_cvt_pk_bf16_f32 v175, v152, v153
  v_mfma_f32_16x16x32_bf16 v[212:215], a[76:79], v[188:191], v[212:215]
  v_mfma_f32_16x16x32_bf16 v[212:215], a[96:99], v[192:195], v[212:215]
  s_nop 7
  ds_write_b128 v231, v[212:215] offset:17408
  s_waitcnt vmcnt(0)
  s_cmp_lg_u32 s28, 0
  s_cbranch_scc1 L_al_73
  global_load_dword v246, v244, s[50:51] sc1
  global_load_dword v247, v245, s[50:51] sc1
L_al_73:
  v_mfma_f32_16x16x32_bf16 v[140:143], v[76:79], v[44:47], 0
  v_mfma_f32_16x16x32_bf16 v[144:147], v[80:83], v[44:47], 0
  v_mfma_f32_16x16x32_bf16 v[148:151], v[84:87], v[48:51], 0
  v_mfma_f32_16x16x32_bf16 v[152:155], v[88:91], v[48:51], 0
  v_mfma_f32_16x16x32_bf16 v[196:199], a[0:3], v[156:159], 0
  v_mfma_f32_16x16x32_bf16 v[196:199], a[20:23], v[160:163], v[196:199]
  v_mfma_f32_16x16x32_bf16 v[196:199], a[40:43], v[164:167], v[196:199]
  s_nop 1
  v_add_f32 v216, s58, v143
  v_rcp_f32 v216, v216
  s_nop 0
  v_pk_mul_f32 v[140:141], v[140:141], v[216:217] op_sel:[0,0] op_sel_hi:[1,0]
  v_mul_f32 v142, v142, v216
  v_pk_mul_f32 v[144:145], v[144:145], v[216:217] op_sel:[0,0] op_sel_hi:[1,0]
  v_cvt_pk_bf16_f32 v176, v140, v141
  v_cvt_pk_bf16_f32 v177, v144, v145
  v_mfma_f32_16x16x32_bf16 v[196:199], a[60:63], v[168:171], v[196:199]
  v_mfma_f32_16x16x32_bf16 v[196:199], a[80:83], v[172:175], v[196:199]
  v_add_f32 v218, s58, v151
  v_rcp_f32 v218, v218
  s_nop 0
  v_pk_mul_f32 v[148:149], v[148:149], v[218:219] op_sel:[0,0] op_sel_hi:[1,0]
  v_mul_f32 v150, v150, v218
  v_pk_mul_f32 v[152:153], v[152:153], v[218:219] op_sel:[0,0] op_sel_hi:[1,0]
  v_cvt_pk_bf16_f32 v178, v142, v150
  v_cvt_pk_bf16_f32 v179, v148, v149
  v_cvt_pk_bf16_f32 v180, v152, v153
  v_mfma_f32_16x16x32_bf16 v[200:203], a[4:7], v[156:159], 0
  v_mfma_f32_16x16x32_bf16 v[140:143], v[92:95], v[52:55], 0
  v_mfma_f32_16x16x32_bf16 v[144:147], v[96:99], v[52:55], 0
  v_mfma_f32_16x16x32_bf16 v[148:151], v[100:103], v[56:59], 0
  v_mfma_f32_16x16x32_bf16 v[152:155], v[104:107], v[56:59], 0
  v_mfma_f32_16x16x32_bf16 v[200:203], a[24:27], v[160:163], v[200:203]
  v_mfma_f32_16x16x32_bf16 v[200:203], a[44:47], v[164:167], v[200:203]
  ds_write_b128 v231, v[196:199] offset:18432
  v_mfma_f32_16x16x32_bf16 v[200:203], a[64:67], v[168:171], v[200:203]
  s_nop 0
  v_add_f32 v216, s58, v143
  v_rcp_f32 v216, v216
  s_nop 0
  v_pk_mul_f32 v[140:141], v[140:141], v[216:217] op_sel:[0,0] op_sel_hi:[1,0]
  v_mul_f32 v142, v142, v216
  v_pk_mul_f32 v[144:145], v[144:145], v[216:217] op_sel:[0,0] op_sel_hi:[1,0]
  v_cvt_pk_bf16_f32 v181, v140, v141
  v_cvt_pk_bf16_f32 v182, v144, v145
  v_mfma_f32_16x16x32_bf16 v[200:203], a[84:87], v[172:175], v[200:203]
  v_mfma_f32_16x16x32_bf16 v[204:207], a[8:11], v[156:159], 0
  v_add_f32 v218, s58, v151
  v_rcp_f32 v218, v218
  s_nop 0
  v_pk_mul_f32 v[148:149], v[148:149], v[218:219] op_sel:[0,0] op_sel_hi:[1,0]
  v_mul_f32 v150, v150, v218
  v_pk_mul_f32 v[152:153], v[152:153], v[218:219] op_sel:[0,0] op_sel_hi:[1,0]
  v_cvt_pk_bf16_f32 v183, v142, v150
  v_cvt_pk_bf16_f32 v184, v148, v149
  v_cvt_pk_bf16_f32 v185, v152, v153
  v_mfma_f32_16x16x32_bf16 v[204:207], a[28:31], v[160:163], v[204:207]
  v_mfma_f32_16x16x32_bf16 v[140:143], v[108:111], v[60:63], 0
  v_mfma_f32_16x16x32_bf16 v[144:147], v[112:115], v[60:63], 0
  v_mfma_f32_16x16x32_bf16 v[148:151], v[116:119], v[64:67], 0
  v_mfma_f32_16x16x32_bf16 v[152:155], v[120:123], v[64:67], 0
  v_mfma_f32_16x16x32_bf16 v[204:207], a[48:51], v[164:167], v[204:207]
  ds_write_b128 v231, v[200:203] offset:19456
  v_mfma_f32_16x16x32_bf16 v[204:207], a[68:71], v[168:171], v[204:207]
  v_mfma_f32_16x16x32_bf16 v[204:207], a[88:91], v[172:175], v[204:207]
  s_nop 0
  v_add_f32 v216, s58, v143
  v_rcp_f32 v216, v216
  s_nop 0
  v_pk_mul_f32 v[140:141], v[140:141], v[216:217] op_sel:[0,0] op_sel_hi:[1,0]
  v_mul_f32 v142, v142, v216
  v_pk_mul_f32 v[144:145], v[144:145], v[216:217] op_sel:[0,0] op_sel_hi:[1,0]
  v_cvt_pk_bf16_f32 v186, v140, v141
  v_cvt_pk_bf16_f32 v187, v144, v145
  v_mfma_f32_16x16x32_bf16 v[208:211], a[12:15], v[156:159], 0
  v_mfma_f32_16x16x32_bf16 v[208:211], a[32:35], v[160:163], v[208:211]
  v_add_f32 v218, s58, v151
  v_rcp_f32 v218, v218
  s_nop 0
  v_pk_mul_f32 v[148:149], v[148:149], v[218:219] op_sel:[0,0] op_sel_hi:[1,0]
  v_mul_f32 v150, v150, v218
  v_pk_mul_f32 v[152:153], v[152:153], v[218:219] op_sel:[0,0] op_sel_hi:[1,0]
  v_cvt_pk_bf16_f32 v188, v142, v150
  v_cvt_pk_bf16_f32 v189, v148, v149
  v_cvt_pk_bf16_f32 v190, v152, v153
  v_mfma_f32_16x16x32_bf16 v[208:211], a[52:55], v[164:167], v[208:211]
  ds_write_b128 v231, v[204:207] offset:20480
  v_mfma_f32_16x16x32_bf16 v[140:143], v[124:127], v[68:71], 0
  v_mfma_f32_16x16x32_bf16 v[144:147], v[128:131], v[68:71], 0
  v_mfma_f32_16x16x32_bf16 v[148:151], v[132:135], v[72:75], 0
  v_mfma_f32_16x16x32_bf16 v[152:155], v[136:139], v[72:75], 0
  v_mfma_f32_16x16x32_bf16 v[208:211], a[72:75], v[168:171], v[208:211]
  v_mfma_f32_16x16x32_bf16 v[208:211], a[92:95], v[172:175], v[208:211]
  v_mfma_f32_16x16x32_bf16 v[212:215], a[16:19], v[156:159], 0
  s_nop 1
  v_add_f32 v216, s58, v143
  v_rcp_f32 v216, v216
  s_nop 0
  v_pk_mul_f32 v[140:141], v[140:141], v[216:217] op_sel:[0,0] op_sel_hi:[1,0]
  v_mul_f32 v142, v142, v216
  v_pk_mul_f32 v[144:145], v[144:145], v[216:217] op_sel:[0,0] op_sel_hi:[1,0]
  v_cvt_pk_bf16_f32 v191, v140, v141
  v_cvt_pk_bf16_f32 v192, v144, v145
  v_mfma_f32_16x16x32_bf16 v[212:215], a[36:39], v[160:163], v[212:215]
  v_mfma_f32_16x16x32_bf16 v[212:215], a[56:59], v[164:167], v[212:215]
  ds_write_b128 v231, v[208:211] offset:21504
  v_add_f32 v218, s58, v151
  v_rcp_f32 v218, v218
  s_nop 0
  v_pk_mul_f32 v[148:149], v[148:149], v[218:219] op_sel:[0,0] op_sel_hi:[1,0]
  v_mul_f32 v150, v150, v218
  v_pk_mul_f32 v[152:153], v[152:153], v[218:219] op_sel:[0,0] op_sel_hi:[1,0]
  v_cvt_pk_bf16_f32 v193, v142, v150
  v_cvt_pk_bf16_f32 v194, v148, v149
  v_cvt_pk_bf16_f32 v195, v152, v153
  v_mfma_f32_16x16x32_bf16 v[212:215], a[76:79], v[168:171], v[212:215]
  v_mfma_f32_16x16x32_bf16 v[212:215], a[96:99], v[172:175], v[212:215]
  s_nop 7
  ds_write_b128 v231, v[212:215] offset:22528
  s_waitcnt vmcnt(0)
  s_cmp_lg_u32 s28, 0
  s_cbranch_scc1 L_cko_75
L_ck_74:
  v_cmp_ne_u32 vcc, s52, v246
  v_cmp_ne_u32 s[30:31], s52, v247
  s_nop 0
  s_or_b64 vcc, vcc, s[30:31]
  s_cmp_eq_u64 vcc, 0
  s_cbranch_scc1 L_cko_75
  s_sleep 2
  s_add_u32 s93, s93, 1
  s_cmp_gt_u32 s93, 300000
  s_cbranch_scc1 L_cko_75
  global_load_dword v246, v244, s[50:51] sc1
  global_load_dword v247, v245, s[50:51] sc1
  s_waitcnt vmcnt(0)
  s_branch L_ck_74
L_cko_75:
  s_barrier
  global_load_dwordx4 v[76:79], v228, s[50:51] sc1
  v_add_u32 v228, 32768, v228
  global_load_dwordx4 v[80:83], v228, s[50:51] sc1
  v_add_u32 v228, 32768, v228
  s_mov_b64 exec, 0xffffffff
  global_load_dwordx4 v[84:87], v228, s[50:51] sc1
  s_mov_b64 exec, -1
  global_load_dword v224, v230, s[50:51] sc1
  v_add_u32 v230, 8192, v230
  global_load_dword v225, v230, s[50:51] sc1
  v_add_u32 v230, 8192, v230
  global_load_dword v226, v230, s[50:51] sc1
  v_add_u32 v230, 8192, v230
  global_load_dword v227, v230, s[50:51] sc1
  v_mfma_f32_16x16x32_bf16 v[196:199], a[0:3], v[176:179], 0
  v_mfma_f32_16x16x32_bf16 v[196:199], a[20:23], v[180:183], v[196:199]
  v_mfma_f32_16x16x32_bf16 v[196:199], a[40:43], v[184:187], v[196:199]
  v_mfma_f32_16x16x32_bf16 v[196:199], a[60:63], v[188:191], v[196:199]
  v_mfma_f32_16x16x32_bf16 v[196:199], a[80:83], v[192:195], v[196:199]
  v_mfma_f32_16x16x32_bf16 v[200:203], a[4:7], v[176:179], 0
  v_mfma_f32_16x16x32_bf16 v[200:203], a[24:27], v[180:183], v[200:203]
  v_mfma_f32_16x16x32_bf16 v[200:203], a[44:47], v[184:187], v[200:203]
  v_mfma_f32_16x16x32_bf16 v[200:203], a[64:67], v[188:191], v[200:203]
  v_mfma_f32_16x16x32_bf16 v[200:203], a[84:87], v[192:195], v[200:203]
  v_mfma_f32_16x16x32_bf16 v[204:207], a[8:11], v[176:179], 0
  v_mfma_f32_16x16x32_bf16 v[204:207], a[28:31], v[180:183], v[204:207]
  v_mfma_f32_16x16x32_bf16 v[204:207], a[48:51], v[184:187], v[204:207]
  v_mfma_f32_16x16x32_bf16 v[204:207], a[68:71], v[188:191], v[204:207]
  v_mfma_f32_16x16x32_bf16 v[204:207], a[88:91], v[192:195], v[204:207]
  v_mfma_f32_16x16x32_bf16 v[208:211], a[12:15], v[176:179], 0
  v_mfma_f32_16x16x32_bf16 v[208:211], a[32:35], v[180:183], v[208:211]
  v_mfma_f32_16x16x32_bf16 v[208:211], a[52:55], v[184:187], v[208:211]
  v_mfma_f32_16x16x32_bf16 v[208:211], a[72:75], v[188:191], v[208:211]
  v_mfma_f32_16x16x32_bf16 v[208:211], a[92:95], v[192:195], v[208:211]
  v_mfma_f32_16x16x32_bf16 v[212:215], a[16:19], v[176:179], 0
  v_mfma_f32_16x16x32_bf16 v[212:215], a[36:39], v[180:183], v[212:215]
  v_mfma_f32_16x16x32_bf16 v[212:215], a[56:59], v[184:187], v[212:215]
  v_mfma_f32_16x16x32_bf16 v[212:215], a[76:79], v[188:191], v[212:215]
  v_mfma_f32_16x16x32_bf16 v[212:215], a[96:99], v[192:195], v[212:215]
  s_add_u32 s29, s28, 1
  s_and_b32 s29, s29, 3
  s_mul_i32 s29, s29, 25600
  s_add_u32 s29, s29, 18432
  v_add_u32 v4, s29, v7
  s_add_u32 s29, s28, 2
  s_and_b32 s29, s29, 3
  s_mul_i32 s29, s29, 25600
  s_add_u32 s29, s29, 13312
  v_add_u32 v5, s29, v7
  s_add_u32 s29, s28, 3
  s_and_b32 s29, s29, 3
  s_mul_i32 s29, s29, 25600
  s_add_u32 s29, s29, 8192
  v_add_u32 v6, s29, v7
  s_waitcnt vmcnt(0)
  ds_write_b128 v229, v[76:79] offset:0
  ds_write_b128 v229, v[80:83] offset:1024
  s_mov_b64 exec, 0xffffffff
  ds_write_b128 v229, v[84:87] offset:2048
  s_mov_b64 exec, -1
  s_waitcnt lgkmcnt(0)
  s_barrier
  ds_read_b128 v[12:15], v4 offset:0
  ds_read_b128 v[32:35], v5 offset:0
  ds_read_b128 v[52:55], v6 offset:0
  ds_read_b64_tr_b16 v[92:93], v221 offset:0
  ds_read_b128 v[16:19], v4 offset:1024
  ds_read_b128 v[36:39], v5 offset:1024
  ds_read_b128 v[56:59], v6 offset:1024
  ds_read_b64_tr_b16 v[100:101], v221 offset:2048
  ds_read_b128 v[20:23], v4 offset:2048
  ds_read_b128 v[40:43], v5 offset:2048
  ds_read_b128 v[60:63], v6 offset:2048
  ds_read_b64_tr_b16 v[108:109], v221 offset:4096
  ds_read_b128 v[24:27], v4 offset:3072
  ds_read_b128 v[44:47], v5 offset:3072
  ds_read_b128 v[64:67], v6 offset:3072
  ds_read_b64_tr_b16 v[116:117], v221 offset:6144
  ds_read_b128 v[28:31], v4 offset:4096
  ds_read_b128 v[48:51], v5 offset:4096
  ds_read_b128 v[68:71], v6 offset:4096
  ds_read_b64_tr_b16 v[124:125], v221 offset:8192
  v_add_f32 v224, v224, v225
  v_add_f32 v226, v226, v227
  v_add_f32 v220, v224, v226
  v_cvt_pk_bf16_f32 v220, v220, v220
  v_lshlrev_b32 v220, 16, v220
  v_mul_f32 v220, 3216550459, v220
  v_exp_f32 v220, v220
  s_nop 0
  v_add_f32 v220, 1.0, v220
  v_rcp_f32 v220, v220
  s_nop 0
  v_cvt_pk_bf16_f32 v220, v220, v220
  v_lshlrev_b32 v220, 16, v220
  v_mov_b32 v216, v220
  v_sub_f32 v218, 1.0, v220
  v_cvt_pk_bf16_f32 v218, v218, v218
  v_lshlrev_b32 v218, 16, v218
  s_waitcnt lgkmcnt(15)
  v_pk_add_f32 v[196:197], v[196:197], v[12:13]
  v_pk_add_f32 v[32:33], v[32:33], v[52:53]
  v_pk_add_f32 v[196:197], v[196:197], v[32:33]
  v_pk_mul_f32 v[196:197], v[196:197], v[218:219] op_sel:[0,0] op_sel_hi:[1,0]
  v_pk_add_f32 v[198:199], v[198:199], v[14:15]
  v_pk_add_f32 v[34:35], v[34:35], v[54:55]
  v_pk_add_f32 v[198:199], v[198:199], v[34:35]
  v_pk_mul_f32 v[198:199], v[198:199], v[218:219] op_sel:[0,0] op_sel_hi:[1,0]
  v_lshlrev_b32 v140, 16, v92
  v_and_b32 v141, 0xffff0000, v92
  v_lshlrev_b32 v142, 16, v93
  v_and_b32 v143, 0xffff0000, v93
  v_pk_fma_f32 v[196:197], v[140:141], v[216:217], v[196:197] op_sel:[0,0,0] op_sel_hi:[1,0,1]
  v_pk_fma_f32 v[198:199], v[142:143], v[216:217], v[198:199] op_sel:[0,0,0] op_sel_hi:[1,0,1]
  v_cvt_pk_bf16_f32 v156, v196, v197
  v_cvt_pk_bf16_f32 v157, v198, v199
  s_waitcnt lgkmcnt(12)
  v_pk_add_f32 v[200:201], v[200:201], v[16:17]
  v_pk_add_f32 v[36:37], v[36:37], v[56:57]
  v_pk_add_f32 v[200:201], v[200:201], v[36:37]
  v_pk_mul_f32 v[200:201], v[200:201], v[218:219] op_sel:[0,0] op_sel_hi:[1,0]
  v_pk_add_f32 v[202:203], v[202:203], v[18:19]
  v_pk_add_f32 v[38:39], v[38:39], v[58:59]
  v_pk_add_f32 v[202:203], v[202:203], v[38:39]
  v_pk_mul_f32 v[202:203], v[202:203], v[218:219] op_sel:[0,0] op_sel_hi:[1,0]
  v_lshlrev_b32 v148, 16, v100
  v_and_b32 v149, 0xffff0000, v100
  v_lshlrev_b32 v150, 16, v101
  v_and_b32 v151, 0xffff0000, v101
  v_pk_fma_f32 v[200:201], v[148:149], v[216:217], v[200:201] op_sel:[0,0,0] op_sel_hi:[1,0,1]
  v_pk_fma_f32 v[202:203], v[150:151], v[216:217], v[202:203] op_sel:[0,0,0] op_sel_hi:[1,0,1]
  v_cvt_pk_bf16_f32 v158, v200, v201
  v_cvt_pk_bf16_f32 v159, v202, v203
  s_nop 0
  v_permlane16_swap_b32 v156, v158
  v_permlane16_swap_b32 v157, v159
  global_store_dwordx4 v223, v[156:159], s[16:17] offset:0
  s_waitcnt lgkmcnt(8)
  v_pk_add_f32 v[204:205], v[204:205], v[20:21]
  v_pk_add_f32 v[40:41], v[40:41], v[60:61]
  v_pk_add_f32 v[204:205], v[204:205], v[40:41]
  v_pk_mul_f32 v[204:205], v[204:205], v[218:219] op_sel:[0,0] op_sel_hi:[1,0]
  v_pk_add_f32 v[206:207], v[206:207], v[22:23]
  v_pk_add_f32 v[42:43], v[42:43], v[62:63]
  v_pk_add_f32 v[206:207], v[206:207], v[42:43]
  v_pk_mul_f32 v[206:207], v[206:207], v[218:219] op_sel:[0,0] op_sel_hi:[1,0]
  v_lshlrev_b32 v140, 16, v108
  v_and_b32 v141, 0xffff0000, v108
  v_lshlrev_b32 v142, 16, v109
  v_and_b32 v143, 0xffff0000, v109
  v_pk_fma_f32 v[204:205], v[140:141], v[216:217], v[204:205] op_sel:[0,0,0] op_sel_hi:[1,0,1]
  v_pk_fma_f32 v[206:207], v[142:143], v[216:217], v[206:207] op_sel:[0,0,0] op_sel_hi:[1,0,1]
  v_cvt_pk_bf16_f32 v160, v204, v205
  v_cvt_pk_bf16_f32 v161, v206, v207
  s_waitcnt lgkmcnt(4)
  v_pk_add_f32 v[208:209], v[208:209], v[24:25]
  v_pk_add_f32 v[44:45], v[44:45], v[64:65]
  v_pk_add_f32 v[208:209], v[208:209], v[44:45]
  v_pk_mul_f32 v[208:209], v[208:209], v[218:219] op_sel:[0,0] op_sel_hi:[1,0]
  v_pk_add_f32 v[210:211], v[210:211], v[26:27]
  v_pk_add_f32 v[46:47], v[46:47], v[66:67]
  v_pk_add_f32 v[210:211], v[210:211], v[46:47]
  v_pk_mul_f32 v[210:211], v[210:211], v[218:219] op_sel:[0,0] op_sel_hi:[1,0]
  v_lshlrev_b32 v148, 16, v116
  v_and_b32 v149, 0xffff0000, v116
  v_lshlrev_b32 v150, 16, v117
  v_and_b32 v151, 0xffff0000, v117
  v_pk_fma_f32 v[208:209], v[148:149], v[216:217], v[208:209] op_sel:[0,0,0] op_sel_hi:[1,0,1]
  v_pk_fma_f32 v[210:211], v[150:151], v[216:217], v[210:211] op_sel:[0,0,0] op_sel_hi:[1,0,1]
  v_cvt_pk_bf16_f32 v162, v208, v209
  v_cvt_pk_bf16_f32 v163, v210, v211
  s_nop 0
  v_permlane16_swap_b32 v160, v162
  v_permlane16_swap_b32 v161, v163
  global_store_dwordx4 v223, v[160:163], s[16:17] offset:64
  s_waitcnt lgkmcnt(0)
  v_pk_add_f32 v[212:213], v[212:213], v[28:29]
  v_pk_add_f32 v[48:49], v[48:49], v[68:69]
  v_pk_add_f32 v[212:213], v[212:213], v[48:49]
  v_pk_mul_f32 v[212:213], v[212:213], v[218:219] op_sel:[0,0] op_sel_hi:[1,0]
  v_pk_add_f32 v[214:215], v[214:215], v[30:31]
  v_pk_add_f32 v[50:51], v[50:51], v[70:71]
  v_pk_add_f32 v[214:215], v[214:215], v[50:51]
  v_pk_mul_f32 v[214:215], v[214:215], v[218:219] op_sel:[0,0] op_sel_hi:[1,0]
  v_lshlrev_b32 v140, 16, v124
  v_and_b32 v141, 0xffff0000, v124
  v_lshlrev_b32 v142, 16, v125
  v_and_b32 v143, 0xffff0000, v125
  v_pk_fma_f32 v[212:213], v[140:141], v[216:217], v[212:213] op_sel:[0,0,0] op_sel_hi:[1,0,1]
  v_pk_fma_f32 v[214:215], v[142:143], v[216:217], v[214:215] op_sel:[0,0,0] op_sel_hi:[1,0,1]
  v_cvt_pk_bf16_f32 v164, v212, v213
  v_cvt_pk_bf16_f32 v165, v214, v215
  global_store_dwordx2 v222, v[164:165], s[16:17] offset:128
L_end:
  s_endpgm
.section .rodata,"a"
.p2align 6
.amdhsa_kernel gated_mix__ssm_conv_s4__linear_attn_block__prompt_kernel
  .amdhsa_next_free_vgpr 356
  .amdhsa_next_free_sgpr 102
  .amdhsa_accum_offset 256
  .amdhsa_group_segment_fixed_size 0
  .amdhsa_kernarg_size 128
  .amdhsa_user_sgpr_count 2
  .amdhsa_user_sgpr_kernarg_segment_ptr 1
  .amdhsa_system_sgpr_workgroup_id_x 1
.end_amdhsa_kernel
```
